```python
import torch

def _softmax(x, axis=-1):
    return torch.softmax(x, dim=axis)
def _gelu(x):
    return torch.nn.functional.gelu(x, approximate="tanh")
def _silu(x):
    return torch.nn.functional.silu(x)
def _sigmoid(x):
    return torch.sigmoid(x)
def _layernorm(x, axis=-1, eps=1e-5):
    m = x.mean(dim=axis, keepdim=True)
    v = x.var(dim=axis, keepdim=True, unbiased=False)
    return (x - m) / torch.sqrt(v + eps)
def _scatter_add(tgt, idx, src, axis=0):
    return tgt.clone().index_add_(axis, idx, src)
def _segment_sum(src, seg, n):
    out = torch.zeros((n,) + src.shape[1:], dtype=src.dtype)
    return out.index_add_(0, seg, src)
def _pad(x, pw):
    flat = tuple(v for pair in reversed(pw) for v in pair)
    return torch.nn.functional.pad(x, flat)

kernel_name = 'sequential_preLN__grouped_kv_mqa__moe_arch_mod__prompt'

def setup_inputs():

    _w = (lambda a: (lambda t: t.to(torch.bfloat16) if t.is_floating_point() else t)(torch.as_tensor(a)))
    def _A_setup():
        B, S, D, H = 1, 2048, 512, 32
        Dh = D // H
        return {
            "x": _w((lambda *s: torch.randn(*s, dtype=torch.bfloat16) * 0.05)(B, S, D)),
            "wq": _w((lambda *s: torch.randn(*s, dtype=torch.bfloat16) * 0.2)(D, H * Dh)),
            "wk": _w((lambda *s: torch.randn(*s, dtype=torch.bfloat16) * 0.2)(D, Dh)),
            "wv": _w((lambda *s: torch.randn(*s, dtype=torch.bfloat16) * 0.2)(D, Dh)),
            "wo": _w((lambda *s: torch.randn(*s, dtype=torch.bfloat16) * 0.2)(H * Dh, D)),
        }
    _A_in = _A_setup()

    def _B_setup():
        B, S, D, F, C = 1, 2048, 512, 1376, 2
        return {
            "x": _w((lambda *s: torch.randn(*s, dtype=torch.bfloat16) * 0.05)(B, S, D)),
            "w_r": _w((lambda *s: torch.randn(*s, dtype=torch.bfloat16) * 0.2)(D)),
            "w_gate": _w((lambda *s: torch.randn(*s, dtype=torch.bfloat16) * 0.2)(D, F)),
            "w_up": _w((lambda *s: torch.randn(*s, dtype=torch.bfloat16) * 0.2)(D, F)),
            "w_down": _w((lambda *s: torch.randn(*s, dtype=torch.bfloat16) * 0.2)(F, D)),
        }
    _B_in = _B_setup()

    return {
        "A_x": _A_in["x"],
        "A_wq": _A_in["wq"],
        "A_wk": _A_in["wk"],
        "A_wv": _A_in["wv"],
        "A_wo": _A_in["wo"],
        "B_x": _B_in["x"],
        "B_w_r": _B_in["w_r"],
        "B_w_gate": _B_in["w_gate"],
        "B_w_up": _B_in["w_up"],
        "B_w_down": _B_in["w_down"],
    }

def reference(A_x, A_wq, A_wk, A_wv, A_wo, B_x, B_w_r, B_w_gate, B_w_up, B_w_down):
    def _A_ref(x, wq, wk, wv, wo):
        B, S, D = x.shape
        H = 32
        Dh = D // H
        q = (lambda x, *d: x.permute(*d))((x @ wq).reshape(B, S, H, Dh), 0, 2, 1, 3)
        k = x @ wk
        v = x @ wv
        scores = torch.einsum("bhqd,bkd->bhqk", q, k) * (Dh ** -0.5)
        p = _softmax(scores, axis=-1)
        o = torch.einsum("bhqk,bkd->bhqd", p, v)
        return (lambda x, *d: x.permute(*d))(o, 0, 2, 1, 3).reshape(B, S, H * Dh) @ wo

    def _B_ref(x, w_r, w_gate, w_up, w_down):
        B, S, D = x.shape
        C = 2
        r = x @ w_r
        idx = torch.argsort(-r, axis=-1)[:, :C]
        idx_e = (lambda x, n, axis: torch.repeat_interleave(x, n, dim=axis))(idx.reshape(B, C, 1), D, axis=2)
        x_sel = (lambda x, i, axis: torch.take_along_dim(x, i, dim=axis))(x, idx_e, axis=1)
        g = _silu(x_sel @ w_gate)
        u = x_sel @ w_up
        y = (g * u) @ w_down
        r_sel = _sigmoid((lambda x, i, axis: torch.take_along_dim(x, i, dim=axis))(r, idx, axis=1))
        y = y * r_sel.reshape(B, C, 1)
        b_off = (torch.arange(B) * S).reshape(B, 1)
        flat_idx = (idx + b_off).reshape(B * C)
        zero = (x * 0.0).reshape(B * S, D)
        upd = _scatter_add(zero, flat_idx, y.reshape(B * C, D), axis=0)
        return x + upd.reshape(B, S, D)

    x = A_x
    h = x + _A_ref(_layernorm(x, axis=-1), A_wq, A_wk, A_wv, A_wo)
    h2 = h + _B_ref(_layernorm(h, axis=-1), B_w_r, B_w_gate, B_w_up, B_w_down)
    return h2
```

```asm
; @launch grid=(256,1,1) block=(512,1,1) lds=160960
.amdgcn_target "amdgcn-amd-amdhsa--gfx950"
.text
    .globl sequential_preLN__grouped_kv_mqa__moe_arch_mod__prompt_kernel
    .p2align 8
    .type sequential_preLN__grouped_kv_mqa__moe_arch_mod__prompt_kernel,@function
sequential_preLN__grouped_kv_mqa__moe_arch_mod__prompt_kernel:
    s_cmp_ge_u32 s2, 256
    s_cbranch_scc1 L2_end
    s_load_dwordx8 s[4:11], s[0:1], 0
    s_load_dwordx2 s[12:13], s[0:1], 32
    s_load_dwordx2 s[14:15], s[0:1], 96
    s_load_dwordx2 s[64:65], s[0:1], 88
    v_lshrrev_b32 v1, 6, v0
    v_and_b32 v2, 63, v0
    v_readfirstlane_b32 s40, v1
    s_and_b32 s43, s2, 7
    s_lshr_b32 s44, s2, 3
    s_and_b32 s45, s44, 3
    s_lshl_b32 s41, s43, 2
    s_add_u32 s41, s41, s45
    s_lshr_b32 s42, s44, 2
    v_and_b32 v3, 15, v2
    v_lshrrev_b32 v4, 4, v2
    v_lshlrev_b32 v13, 4, v2
    s_and_b32 s46, s40, 3
    s_lshl_b32 s50, s46, 12
    s_and_b32 s58, s42, 3
    s_cmp_lt_u32 s40, 4
    s_cbranch_scc1 L1_gemm
    v_add_u32 v7, 0, v4
    v_xor_b32 v16, v7, v3
    v_lshlrev_b32 v16, 4, v16
    v_lshl_add_u32 v16, v7, 10, v16
    v_add_u32 v7, 4, v4
    v_xor_b32 v17, v7, v3
    v_lshlrev_b32 v17, 4, v17
    v_lshl_add_u32 v17, v7, 10, v17
    v_add_u32 v7, 8, v4
    v_xor_b32 v18, v7, v3
    v_lshlrev_b32 v18, 4, v18
    v_lshl_add_u32 v18, v7, 10, v18
    v_add_u32 v7, 12, v4
    v_xor_b32 v19, v7, v3
    v_lshlrev_b32 v19, 4, v19
    v_lshl_add_u32 v19, v7, 10, v19
    v_lshrrev_b32 v7, 3, v2
    v_and_b32 v22, 1, v4
    v_lshlrev_b32 v22, 2, v22
    v_and_b32 v14, 7, v2
    v_xor_b32 v22, v22, v14
    v_lshlrev_b32 v22, 4, v22
    v_lshl_add_u32 v22, v7, 10, v22
    s_lshl_b32 s48, s41, 16
    s_lshl_b32 s43, s46, 14
    s_add_u32 s48, s48, s43
    s_lshl_b32 s49, s46, 15
    s_lshl_b32 s43, s42, 7
    s_add_u32 s49, s49, s43
    s_add_u32 s55, s42, s41
    s_waitcnt lgkmcnt(0)
    s_mov_b32 s16, s4
    s_and_b32 s17, s5, 0xffff
    s_mov_b32 s18, 2097152
    s_mov_b32 s19, 0x20000
    s_add_u32 s43, s55, 0
    s_and_b32 s43, s43, 3
    s_lshl_b32 s43, s43, 8
    s_add_u32 s51, s48, s43
    s_add_u32 m0, s50, 0
    s_nop 0
    buffer_load_dwordx4 v16, s[16:19], s51 offen lds
    s_add_u32 m0, s50, 1024
    s_nop 0
    buffer_load_dwordx4 v17, s[16:19], s51 offen lds
    s_add_u32 m0, s50, 2048
    s_nop 0
    buffer_load_dwordx4 v18, s[16:19], s51 offen lds
    s_add_u32 m0, s50, 3072
    s_nop 0
    buffer_load_dwordx4 v19, s[16:19], s51 offen lds
    s_cmp_ge_u32 s42, 4
    s_cselect_b32 s8, s10, s8
    s_cselect_b32 s9, s11, s9
    s_lshl_b32 s61, s46, 10
    s_mov_b32 s24, s8
    s_and_b32 s25, s9, 0xffff
    s_mov_b32 s26, 16384
    s_mov_b32 s27, 0x20000
    s_add_u32 s43, s55, 0
    s_and_b32 s43, s43, 3
    s_lshl_b32 s43, s43, 12
    s_add_u32 m0, s61, 131072
    s_add_u32 s52, s61, s43
    buffer_load_dwordx4 v13, s[24:27], s52 offen lds
    s_add_u32 s43, s55, 1
    s_and_b32 s43, s43, 3
    s_lshl_b32 s43, s43, 8
    s_add_u32 s51, s48, s43
    s_add_u32 m0, s50, 16384
    s_nop 0
    buffer_load_dwordx4 v16, s[16:19], s51 offen lds
    s_add_u32 m0, s50, 17408
    s_nop 0
    buffer_load_dwordx4 v17, s[16:19], s51 offen lds
    s_add_u32 m0, s50, 18432
    s_nop 0
    buffer_load_dwordx4 v18, s[16:19], s51 offen lds
    s_add_u32 m0, s50, 19456
    s_nop 0
    buffer_load_dwordx4 v19, s[16:19], s51 offen lds
    s_add_u32 s43, s55, 1
    s_and_b32 s43, s43, 3
    s_lshl_b32 s43, s43, 12
    s_add_u32 m0, s61, 135168
    s_add_u32 s52, s61, s43
    buffer_load_dwordx4 v13, s[24:27], s52 offen lds
    s_mov_b32 s20, s6
    s_and_b32 s21, s7, 0xffff
    s_mov_b32 s22, 524288
    s_mov_b32 s23, 0x20000
    v_mov_b32 v69, 0x3f803f80
    v_add_u32 v30, 149504, v13
    s_lshl_b32 s43, s58, 8
    s_add_u32 s43, s43, 153600
    v_lshl_add_u32 v31, v3, 4, s43
    s_lshl_b32 s56, s41, 1
    s_lshr_b32 s43, s58, 1
    s_add_u32 s56, s56, s43
    s_mul_i32 s56, s56, 2112
    s_add_u32 s56, s56, 2097152
    s_and_b32 s57, s58, 1
    s_lshl_b32 s43, s57, 8
    s_mul_i32 s44, s57, 544
    s_add_u32 s44, s44, 1024
    s_cmp_ge_u32 s42, 4
    s_cselect_b32 s43, s44, s43
    s_cselect_b64 s[62:63], -1, 0
    s_add_u32 s56, s56, s43
    v_and_b32 v14, 1, v4
    v_lshrrev_b32 v15, 1, v4
    v_lshlrev_b32 v26, 9, v14
    v_lshl_add_u32 v26, v15, 3, v26
    v_lshlrev_b32 v27, 8, v15
    v_lshl_add_u32 v27, v14, 3, v27
    v_cndmask_b32 v26, v26, v27, s[62:63]
    v_lshl_add_u32 v26, v3, 4, v26
    s_lshl_b32 s43, s58, 12
    s_lshl_b32 s44, s46, 14
    s_add_u32 s43, s43, s44
    v_lshl_add_u32 v10, v3, 8, s43
    v_xor_b32 v11, v4, v3
    v_lshl_add_u32 v96, v11, 4, v10
    v_xor_b32 v97, 64, v96
    v_xor_b32 v98, 0x80, v96
    v_xor_b32 v99, 0xc0, v96
    v_lshrrev_b32 v9, 2, v3
    v_lshl_add_u32 v95, v4, 3, v9
    v_lshlrev_b32 v95, 5, v95
    v_and_b32 v11, 3, v3
    v_lshl_add_u32 v95, v11, 3, v95
    s_add_u32 s43, s50, 131072
    v_add_u32 v95, s43, v95
    v_add_u32 v24, s61, v30
    s_mov_b32 s36, s14
    s_and_b32 s37, s15, 0xffff
    s_mov_b32 s38, 8388608
    s_mov_b32 s39, 0x20000
    s_mov_b32 s28, s64
    s_and_b32 s29, s65, 0xffff
    s_mov_b32 s30, 256
    s_mov_b32 s31, 0x20000
    v_mov_b32 v93, 154624
    v_mov_b32 v94, 0
    s_add_u32 s43, s55, 2
    s_and_b32 s43, s43, 3
    s_lshl_b32 s43, s43, 8
    s_add_u32 s51, s48, s43
    s_add_u32 m0, s50, 32768
    s_nop 0
    buffer_load_dwordx4 v16, s[16:19], s51 offen lds
    s_add_u32 m0, s50, 33792
    s_nop 0
    buffer_load_dwordx4 v17, s[16:19], s51 offen lds
    s_add_u32 m0, s50, 34816
    s_nop 0
    buffer_load_dwordx4 v18, s[16:19], s51 offen lds
    s_add_u32 m0, s50, 35840
    s_nop 0
    buffer_load_dwordx4 v19, s[16:19], s51 offen lds
    s_add_u32 s43, s55, 2
    s_and_b32 s43, s43, 3
    s_lshl_b32 s43, s43, 12
    s_add_u32 m0, s61, 139264
    s_add_u32 s52, s61, s43
    buffer_load_dwordx4 v13, s[24:27], s52 offen lds
    s_waitcnt vmcnt(10)
    s_barrier
    s_add_u32 s43, s55, 3
    s_and_b32 s43, s43, 3
    s_lshl_b32 s43, s43, 8
    s_add_u32 s51, s48, s43
    s_add_u32 m0, s50, 49152
    s_nop 0
    buffer_load_dwordx4 v16, s[16:19], s51 offen lds
    s_add_u32 m0, s50, 50176
    s_nop 0
    buffer_load_dwordx4 v17, s[16:19], s51 offen lds
    s_add_u32 m0, s50, 51200
    s_nop 0
    buffer_load_dwordx4 v18, s[16:19], s51 offen lds
    s_add_u32 m0, s50, 52224
    s_nop 0
    buffer_load_dwordx4 v19, s[16:19], s51 offen lds
    s_add_u32 s43, s55, 3
    s_and_b32 s43, s43, 3
    s_lshl_b32 s43, s43, 12
    s_add_u32 m0, s61, 143360
    s_add_u32 s52, s61, s43
    buffer_load_dwordx4 v13, s[24:27], s52 offen lds
    s_waitcnt vmcnt(10)
    s_barrier
    s_add_u32 s43, s55, 0
    s_and_b32 s43, s43, 3
    s_lshl_b32 s43, s43, 17
    s_add_u32 s51, s49, s43
    s_add_u32 m0, s50, 65536
    s_add_u32 s52, s51, 0
    buffer_load_dwordx4 v22, s[20:23], s52 offen lds
    s_add_u32 m0, s50, 66560
    s_add_u32 s52, s51, 8192
    buffer_load_dwordx4 v22, s[20:23], s52 offen lds
    s_add_u32 m0, s50, 67584
    s_add_u32 s52, s51, 16384
    buffer_load_dwordx4 v22, s[20:23], s52 offen lds
    s_add_u32 m0, s50, 68608
    s_add_u32 s52, s51, 24576
    buffer_load_dwordx4 v22, s[20:23], s52 offen lds
    s_waitcnt vmcnt(9)
    s_barrier
    s_add_u32 s43, s55, 1
    s_and_b32 s43, s43, 3
    s_lshl_b32 s43, s43, 17
    s_add_u32 s51, s49, s43
    s_add_u32 m0, s50, 81920
    s_add_u32 s52, s51, 0
    buffer_load_dwordx4 v22, s[20:23], s52 offen lds
    s_add_u32 m0, s50, 82944
    s_add_u32 s52, s51, 8192
    buffer_load_dwordx4 v22, s[20:23], s52 offen lds
    s_add_u32 m0, s50, 83968
    s_add_u32 s52, s51, 16384
    buffer_load_dwordx4 v22, s[20:23], s52 offen lds
    s_add_u32 m0, s50, 84992
    s_add_u32 s52, s51, 24576
    buffer_load_dwordx4 v22, s[20:23], s52 offen lds
    s_waitcnt vmcnt(8)
    s_barrier
    ds_read_b128 v[100:103], v96
    ds_read_b128 v[104:107], v97
    ds_read_b128 v[108:111], v98
    ds_read_b128 v[112:115], v99
    ds_read_b64_tr_b16 v[116:117], v95 offset:0
    ds_read_b64_tr_b16 v[118:119], v95 offset:128
    ds_read_b64_tr_b16 v[120:121], v95 offset:1024
    ds_read_b64_tr_b16 v[122:123], v95 offset:1152
    ds_read_b64_tr_b16 v[124:125], v95 offset:2048
    ds_read_b64_tr_b16 v[126:127], v95 offset:2176
    ds_read_b64_tr_b16 v[128:129], v95 offset:3072
    ds_read_b64_tr_b16 v[130:131], v95 offset:3200
    s_waitcnt lgkmcnt(8)
    v_lshlrev_b32 v140, 16, v100
    v_and_b32 v141, 0xffff0000, v100
    v_lshlrev_b32 v142, 16, v101
    v_and_b32 v143, 0xffff0000, v101
    v_lshlrev_b32 v144, 16, v102
    v_and_b32 v145, 0xffff0000, v102
    v_lshlrev_b32 v146, 16, v103
    v_and_b32 v147, 0xffff0000, v103
    v_lshlrev_b32 v148, 16, v104
    v_and_b32 v149, 0xffff0000, v104
    v_lshlrev_b32 v150, 16, v105
    v_and_b32 v151, 0xffff0000, v105
    v_lshlrev_b32 v152, 16, v106
    v_and_b32 v153, 0xffff0000, v106
    v_lshlrev_b32 v154, 16, v107
    v_and_b32 v155, 0xffff0000, v107
    v_lshlrev_b32 v156, 16, v108
    v_and_b32 v157, 0xffff0000, v108
    v_lshlrev_b32 v158, 16, v109
    v_and_b32 v159, 0xffff0000, v109
    v_lshlrev_b32 v160, 16, v110
    v_and_b32 v161, 0xffff0000, v110
    v_lshlrev_b32 v162, 16, v111
    v_and_b32 v163, 0xffff0000, v111
    v_lshlrev_b32 v164, 16, v112
    v_and_b32 v165, 0xffff0000, v112
    v_lshlrev_b32 v166, 16, v113
    v_and_b32 v167, 0xffff0000, v113
    v_lshlrev_b32 v168, 16, v114
    v_and_b32 v169, 0xffff0000, v114
    v_lshlrev_b32 v170, 16, v115
    v_and_b32 v171, 0xffff0000, v115
    s_add_u32 s43, s55, 2
    s_and_b32 s43, s43, 3
    s_lshl_b32 s43, s43, 17
    s_add_u32 s51, s49, s43
    s_add_u32 m0, s50, 98304
    s_add_u32 s52, s51, 0
    buffer_load_dwordx4 v22, s[20:23], s52 offen lds
    s_add_u32 m0, s50, 99328
    s_add_u32 s52, s51, 8192
    buffer_load_dwordx4 v22, s[20:23], s52 offen lds
    s_add_u32 m0, s50, 100352
    s_add_u32 s52, s51, 16384
    buffer_load_dwordx4 v22, s[20:23], s52 offen lds
    s_add_u32 m0, s50, 101376
    s_add_u32 s52, s51, 24576
    buffer_load_dwordx4 v22, s[20:23], s52 offen lds
    s_waitcnt vmcnt(8)
    s_barrier
    s_setprio 2
    ds_read_b128 v[80:83], v31
    buffer_load_dword v66, v94, s[28:31], 0 offen sc1
    s_waitcnt lgkmcnt(0)
    v_add_f32 v8, v80, v82
    v_add_f32 v9, v81, v83
    v_mul_f32 v8, 0xbb000000, v8
    v_mul_f32 v9, 0x3b000000, v9
    v_fma_f32 v9, -v8, v8, v9
    v_max_f32 v9, 0, v9
    v_cvt_pk_bf16_f32 v9, v8, v9
    v_lshlrev_b32 v8, 16, v9
    v_and_b32 v9, 0xffff0000, v9
    v_add_f32 v9, 0x3727c5ac, v9
    v_cvt_pk_bf16_f32 v9, v9, v9
    v_and_b32 v9, 0xffff0000, v9
    v_sqrt_f32 v9, v9
    s_nop 0
    v_cvt_pk_bf16_f32 v9, v9, v9
    v_and_b32 v9, 0xffff0000, v9
    v_rcp_f32 v9, v9
    v_add_f32 v140, v140, v8
    v_add_f32 v141, v141, v8
    v_cvt_pk_bf16_f32 v100, v140, v141
    v_add_f32 v142, v142, v8
    v_add_f32 v143, v143, v8
    v_cvt_pk_bf16_f32 v101, v142, v143
    v_add_f32 v144, v144, v8
    v_add_f32 v145, v145, v8
    v_cvt_pk_bf16_f32 v102, v144, v145
    v_add_f32 v146, v146, v8
    v_add_f32 v147, v147, v8
    v_cvt_pk_bf16_f32 v103, v146, v147
    v_add_f32 v148, v148, v8
    v_add_f32 v149, v149, v8
    v_cvt_pk_bf16_f32 v104, v148, v149
    v_add_f32 v150, v150, v8
    v_add_f32 v151, v151, v8
    v_cvt_pk_bf16_f32 v105, v150, v151
    v_add_f32 v152, v152, v8
    v_add_f32 v153, v153, v8
    v_cvt_pk_bf16_f32 v106, v152, v153
    v_add_f32 v154, v154, v8
    v_add_f32 v155, v155, v8
    v_cvt_pk_bf16_f32 v107, v154, v155
    v_add_f32 v156, v156, v8
    v_add_f32 v157, v157, v8
    v_cvt_pk_bf16_f32 v108, v156, v157
    v_add_f32 v158, v158, v8
    v_add_f32 v159, v159, v8
    v_cvt_pk_bf16_f32 v109, v158, v159
    v_add_f32 v160, v160, v8
    v_add_f32 v161, v161, v8
    v_cvt_pk_bf16_f32 v110, v160, v161
    v_add_f32 v162, v162, v8
    v_add_f32 v163, v163, v8
    v_cvt_pk_bf16_f32 v111, v162, v163
    v_add_f32 v164, v164, v8
    v_add_f32 v165, v165, v8
    v_cvt_pk_bf16_f32 v112, v164, v165
    v_add_f32 v166, v166, v8
    v_add_f32 v167, v167, v8
    v_cvt_pk_bf16_f32 v113, v166, v167
    v_add_f32 v168, v168, v8
    v_add_f32 v169, v169, v8
    v_cvt_pk_bf16_f32 v114, v168, v169
    v_add_f32 v170, v170, v8
    v_add_f32 v171, v171, v8
    v_cvt_pk_bf16_f32 v115, v170, v171
    v_lshlrev_b32 v140, 16, v100
    v_and_b32 v141, 0xffff0000, v100
    v_mul_f32 v140, v140, v9
    v_mul_f32 v141, v141, v9
    v_cvt_pk_bf16_f32 v100, v140, v141
    v_lshlrev_b32 v142, 16, v101
    v_and_b32 v143, 0xffff0000, v101
    v_mul_f32 v142, v142, v9
    v_mul_f32 v143, v143, v9
    v_cvt_pk_bf16_f32 v101, v142, v143
    v_lshlrev_b32 v144, 16, v102
    v_and_b32 v145, 0xffff0000, v102
    v_mul_f32 v144, v144, v9
    v_mul_f32 v145, v145, v9
    v_cvt_pk_bf16_f32 v102, v144, v145
    v_lshlrev_b32 v146, 16, v103
    v_and_b32 v147, 0xffff0000, v103
    v_mul_f32 v146, v146, v9
    v_mul_f32 v147, v147, v9
    v_cvt_pk_bf16_f32 v103, v146, v147
    v_lshlrev_b32 v148, 16, v104
    v_and_b32 v149, 0xffff0000, v104
    v_mul_f32 v148, v148, v9
    v_mul_f32 v149, v149, v9
    v_cvt_pk_bf16_f32 v104, v148, v149
    v_lshlrev_b32 v150, 16, v105
    v_and_b32 v151, 0xffff0000, v105
    v_mul_f32 v150, v150, v9
    v_mul_f32 v151, v151, v9
    v_cvt_pk_bf16_f32 v105, v150, v151
    v_lshlrev_b32 v152, 16, v106
    v_and_b32 v153, 0xffff0000, v106
    v_mul_f32 v152, v152, v9
    v_mul_f32 v153, v153, v9
    v_cvt_pk_bf16_f32 v106, v152, v153
    v_lshlrev_b32 v154, 16, v107
    v_and_b32 v155, 0xffff0000, v107
    v_mul_f32 v154, v154, v9
    v_mul_f32 v155, v155, v9
    v_cvt_pk_bf16_f32 v107, v154, v155
    v_lshlrev_b32 v156, 16, v108
    v_and_b32 v157, 0xffff0000, v108
    v_mul_f32 v156, v156, v9
    v_mul_f32 v157, v157, v9
    v_cvt_pk_bf16_f32 v108, v156, v157
    v_lshlrev_b32 v158, 16, v109
    v_and_b32 v159, 0xffff0000, v109
    v_mul_f32 v158, v158, v9
    v_mul_f32 v159, v159, v9
    v_cvt_pk_bf16_f32 v109, v158, v159
    v_lshlrev_b32 v160, 16, v110
    v_and_b32 v161, 0xffff0000, v110
    v_mul_f32 v160, v160, v9
    v_mul_f32 v161, v161, v9
    v_cvt_pk_bf16_f32 v110, v160, v161
    v_lshlrev_b32 v162, 16, v111
    v_and_b32 v163, 0xffff0000, v111
    v_mul_f32 v162, v162, v9
    v_mul_f32 v163, v163, v9
    v_cvt_pk_bf16_f32 v111, v162, v163
    v_lshlrev_b32 v164, 16, v112
    v_and_b32 v165, 0xffff0000, v112
    v_mul_f32 v164, v164, v9
    v_mul_f32 v165, v165, v9
    v_cvt_pk_bf16_f32 v112, v164, v165
    v_lshlrev_b32 v166, 16, v113
    v_and_b32 v167, 0xffff0000, v113
    v_mul_f32 v166, v166, v9
    v_mul_f32 v167, v167, v9
    v_cvt_pk_bf16_f32 v113, v166, v167
    v_lshlrev_b32 v168, 16, v114
    v_and_b32 v169, 0xffff0000, v114
    v_mul_f32 v168, v168, v9
    v_mul_f32 v169, v169, v9
    v_cvt_pk_bf16_f32 v114, v168, v169
    v_lshlrev_b32 v170, 16, v115
    v_and_b32 v171, 0xffff0000, v115
    v_mul_f32 v170, v170, v9
    v_mul_f32 v171, v171, v9
    v_cvt_pk_bf16_f32 v115, v170, v171
    s_cmp_ge_u32 s42, 4
    s_cbranch_scc1 L1_vm
    v_mfma_f32_16x16x32_bf16 v[132:135], v[116:119], v[100:103], 0
    v_mfma_f32_16x16x32_bf16 v[132:135], v[120:123], v[104:107], v[132:135]
    v_mfma_f32_16x16x32_bf16 v[132:135], v[124:127], v[108:111], v[132:135]
    v_mfma_f32_16x16x32_bf16 v[132:135], v[128:131], v[112:115], v[132:135]
L1_km:
    s_add_u32 s43, s55, 3
    s_and_b32 s43, s43, 3
    s_lshl_b32 s43, s43, 17
    s_add_u32 s51, s49, s43
    s_add_u32 m0, s50, 114688
    s_add_u32 s52, s51, 0
    buffer_load_dwordx4 v22, s[20:23], s52 offen lds
    s_add_u32 m0, s50, 115712
    s_add_u32 s52, s51, 8192
    buffer_load_dwordx4 v22, s[20:23], s52 offen lds
    s_add_u32 m0, s50, 116736
    s_add_u32 s52, s51, 16384
    buffer_load_dwordx4 v22, s[20:23], s52 offen lds
    s_add_u32 m0, s50, 117760
    s_add_u32 s52, s51, 24576
    buffer_load_dwordx4 v22, s[20:23], s52 offen lds
    ds_write_b128 v24, v[132:135]
    s_waitcnt vmcnt(9) lgkmcnt(0)
    s_barrier
    s_cmp_eq_u32 s46, 0
    s_cbranch_scc1 L1_fin
    s_waitcnt vmcnt(4)
L1_find:
    v_readfirstlane_b32 s68, v66
    s_cmp_eq_u32 s68, 0
    s_cbranch_scc1 L1_tag
L1_tagok:
    ds_write_b32 v93, v66
    s_waitcnt lgkmcnt(0)
    s_barrier
    s_lshl_b32 s43, s2, 4
    s_add_u32 s43, s43, 6553600
    s_cmp_eq_u32 s46, 0
    s_cselect_b32 s43, s43, 8388608
    s_waitcnt vmcnt(0)
    s_mov_b64 exec, 1
    buffer_store_dword v66, v94, s[36:39], s43 offen sc0 sc1
    s_mov_b64 exec, -1
    s_barrier
    s_branch L2_start
L1_vm:
    v_mfma_f32_16x16x32_bf16 v[132:135], v[100:103], v[116:119], 0
    v_mfma_f32_16x16x32_bf16 v[132:135], v[104:107], v[120:123], v[132:135]
    v_mfma_f32_16x16x32_bf16 v[132:135], v[108:111], v[124:127], v[132:135]
    v_mfma_f32_16x16x32_bf16 v[132:135], v[112:115], v[128:131], v[132:135]
    s_branch L1_km
L1_fin:
    ds_read_b128 v[36:39], v30 offset:1024
    ds_read_b128 v[40:43], v30 offset:2048
    ds_read_b128 v[44:47], v30 offset:3072
    s_waitcnt lgkmcnt(0)
    v_add_f32 v32, v132, v36
    v_add_f32 v40, v40, v44
    v_add_f32 v33, v133, v37
    v_add_f32 v41, v41, v45
    v_add_f32 v34, v134, v38
    v_add_f32 v42, v42, v46
    v_add_f32 v35, v135, v39
    v_add_f32 v43, v43, v47
    v_add_f32 v32, v32, v40
    v_add_f32 v33, v33, v41
    v_add_f32 v34, v34, v42
    v_add_f32 v35, v35, v43
    v_cvt_pk_bf16_f32 v32, v32, v33
    v_cvt_pk_bf16_f32 v33, v34, v35
    buffer_store_dwordx2 v[32:33], v26, s[36:39], s56 offen sc0 sc1
    s_waitcnt vmcnt(5)
    s_branch L1_find
L1_gemm:
    v_and_b32 v5, 31, v2
    v_lshrrev_b32 v6, 5, v2
    s_and_b32 s53, s40, 1
    s_lshr_b32 s54, s40, 1
    s_lshl_b32 s59, s2, 1
    s_add_u32 s59, s59, s53
    s_lshr_b32 s43, s59, 6
    s_lshl_b32 s47, s43, 7
    s_lshr_b32 s44, s59, 3
    s_and_b32 s44, s44, 7
    s_lshl_b32 s44, s44, 16
    s_add_u32 s47, s47, s44
    s_lshl_b32 s44, s53, 15
    s_add_u32 s47, s47, s44
    s_and_b32 s44, s59, 2
    s_lshl_b32 s44, s44, 5
    s_add_u32 s47, s47, s44
    s_and_b32 s44, s59, 4
    s_lshr_b32 s44, s44, 1
    s_add_u32 s47, s47, s44
    v_lshlrev_b32 v7, 2, v3
    v_lshl_add_u32 v7, v6, 14, v7
    v_and_b32 v8, 1, v4
    v_lshl_add_u32 v7, v8, 12, v7
    v_add_u32 v8, 8192, v7
    s_waitcnt lgkmcnt(0)
    s_mov_b32 s32, s12
    s_and_b32 s33, s13, 0xffff
    s_mov_b32 s34, 524288
    s_mov_b32 s35, 0x20000
    s_mov_b32 s36, s14
    s_and_b32 s37, s15, 0xffff
    s_mov_b32 s38, 8388608
    s_mov_b32 s39, 0x20000
    s_mov_b32 s28, s64
    s_and_b32 s29, s65, 0xffff
    s_mov_b32 s30, 256
    s_mov_b32 s31, 0x20000
    s_cmp_ge_u32 s40, 2
    s_cbranch_scc1 L1_nowo
    buffer_load_ushort v80, v7, s[32:35], s47 offen offset:0
    buffer_load_ushort v81, v7, s[32:35], s47 offen offset:1024
    buffer_load_ushort v82, v8, s[32:35], s47 offen offset:0
    buffer_load_ushort v83, v8, s[32:35], s47 offen offset:1024
    buffer_load_ushort v84, v7, s[32:35], s47 offen offset:2048
    buffer_load_ushort v85, v7, s[32:35], s47 offen offset:3072
    buffer_load_ushort v86, v8, s[32:35], s47 offen offset:2048
    buffer_load_ushort v87, v8, s[32:35], s47 offen offset:3072
    s_branch L1_noz
L1_nowo:
    s_cmp_eq_u32 s40, 2
    s_cbranch_scc1 L1_ini
    s_cmp_lg_u32 s2, 0
    s_cbranch_scc1 L1_noz
    s_memrealtime s[44:45]
    v_mov_b32 v9, 0
    s_waitcnt lgkmcnt(0)
    s_or_b32 s44, s44, 1
    v_mov_b32 v80, s44
    s_mov_b64 exec, 1
    buffer_store_dword v80, v9, s[28:31], 0 offen sc0 sc1
    s_mov_b64 exec, -1
    s_branch L1_noz
L1_ini:
    s_cmp_lt_u32 s2, 172
    s_cselect_b32 s44, -1, 0
    v_mov_b32 v80, s44
    v_mov_b32 v81, 0
    v_lshlrev_b32 v9, 2, v2
    s_lshl_b32 s43, s2, 7
    s_add_u32 s43, s43, 6422528
    s_lshl_b32 s44, s2, 5
    s_add_u32 s44, s44, 6488064
    s_lshr_b32 s45, s2, 1
    s_mul_i32 s45, s45, 2112
    s_and_b32 s48, s2, 1
    s_mul_i32 s48, s48, 544
    s_add_u32 s45, s45, s48
    s_add_u32 s45, s45, 2098688
    s_cmp_lt_u32 s2, 128
    s_cselect_b32 s45, s45, 8388608
    v_cmp_gt_u32 vcc, 4, v2
    v_mov_b32 v82, 0x3f803f80
    s_mov_b64 exec, 0xff
    v_cndmask_b32 v82, 0, v82, vcc
    buffer_store_dword v80, v9, s[36:39], s43 offen sc0 sc1
    buffer_store_dword v82, v9, s[36:39], s45 offen sc0 sc1
    s_mov_b64 exec, 3
    buffer_store_dword v81, v9, s[36:39], s44 offen sc0 sc1
    s_mov_b64 exec, -1
L1_noz:
    s_lshl_b32 s43, s54, 1
    v_xor_b32 v12, s43, v3
    s_lshl_b32 s43, s53, 13
    v_lshlrev_b32 v9, 8, v5
    v_add_u32 v9, s43, v9
    v_add_u32 v10, 0, v6
    v_xor_b32 v10, v10, v12
    v_lshl_add_u32 v72, v10, 4, v9
    v_add_u32 v10, 2, v6
    v_xor_b32 v10, v10, v12
    v_lshl_add_u32 v73, v10, 4, v9
    v_add_u32 v10, 4, v6
    v_xor_b32 v10, v10, v12
    v_lshl_add_u32 v74, v10, 4, v9
    v_add_u32 v10, 6, v6
    v_xor_b32 v10, v10, v12
    v_lshl_add_u32 v75, v10, 4, v9
    v_add_u32 v10, 8, v6
    v_xor_b32 v10, v10, v12
    v_lshl_add_u32 v76, v10, 4, v9
    v_add_u32 v10, 10, v6
    v_xor_b32 v10, v10, v12
    v_lshl_add_u32 v77, v10, 4, v9
    v_add_u32 v10, 12, v6
    v_xor_b32 v10, v10, v12
    v_lshl_add_u32 v78, v10, 4, v9
    v_add_u32 v10, 14, v6
    v_xor_b32 v10, v10, v12
    v_lshl_add_u32 v79, v10, 4, v9
    v_lshrrev_b32 v9, 2, v3
    v_lshl_add_u32 v10, v6, 3, v9
    v_lshlrev_b32 v10, 7, v10
    v_lshrrev_b32 v11, 1, v9
    v_xor_b32 v11, s54, v11
    v_lshl_add_u32 v10, v11, 6, v10
    v_and_b32 v11, 1, v4
    v_lshl_add_u32 v10, v11, 5, v10
    v_and_b32 v11, 3, v3
    v_lshl_add_u32 v10, v11, 3, v10
    s_lshl_b32 s43, s54, 11
    s_add_u32 s44, s43, 0x10000
    s_sub_u32 s43, 67584, s43
    v_add_u32 v68, s44, v10
    v_add_u32 v70, s43, v10
    v_lshrrev_b32 v64, 3, v5
    v_lshlrev_b32 v64, 13, v64
    v_and_b32 v11, 7, v5
    v_lshl_add_u32 v64, v11, 4, v64
    v_lshl_add_u32 v64, v6, 9, v64
    s_lshl_b32 s60, s41, 16
    s_lshl_b32 s44, s53, 15
    s_add_u32 s60, s60, s44
    s_lshl_b32 s44, s42, 10
    s_add_u32 s60, s60, s44
    s_lshl_b32 s44, s54, 8
    s_add_u32 s60, s60, s44
    s_add_u32 s60, s60, 0
    s_lshl_b32 s43, s53, 9
    s_add_u32 s43, s43, 153600
    v_lshl_add_u32 v67, v5, 4, s43
    s_lshl_b32 s43, s54, 3
    v_lshl_add_u32 v65, v6, 2, v67
    v_add_u32 v65, s43, v65
    s_lshl_b32 s59, s59, 10
    s_add_u32 s59, s59, 3145728
    s_cmp_ge_u32 s40, 2
    s_cselect_b32 s59, 8388608, s59
    v_mov_b32 v69, 0x3f803f80
    v_mov_b32 v14, 0
    v_mov_b32 v15, 0
    v_mov_b32 v90, 0
    v_mov_b32 v91, 0
    v_mov_b32 v250, 0
    v_mov_b32 v251, 0
    s_barrier
    ds_read_b128 v[120:123], v72 offset:0
    ds_read_b128 v[128:131], v74 offset:0
    ds_read_b128 v[136:139], v76 offset:0
    ds_read_b128 v[144:147], v78 offset:0
    ds_read_b128 v[124:127], v73 offset:0
    ds_read_b128 v[132:135], v75 offset:0
    ds_read_b128 v[140:143], v77 offset:0
    ds_read_b128 v[148:151], v79 offset:0
    s_waitcnt lgkmcnt(7)
    v_dot2c_f32_bf16 v14, v120, v69
    v_dot2c_f32_bf16 v15, v120, v120
    v_dot2c_f32_bf16 v14, v121, v69
    v_dot2c_f32_bf16 v15, v121, v121
    v_dot2c_f32_bf16 v14, v122, v69
    v_dot2c_f32_bf16 v15, v122, v122
    v_dot2c_f32_bf16 v14, v123, v69
    v_dot2c_f32_bf16 v15, v123, v123
    s_waitcnt lgkmcnt(6)
    v_dot2c_f32_bf16 v14, v128, v69
    v_dot2c_f32_bf16 v15, v128, v128
    v_dot2c_f32_bf16 v14, v129, v69
    v_dot2c_f32_bf16 v15, v129, v129
    v_dot2c_f32_bf16 v14, v130, v69
    v_dot2c_f32_bf16 v15, v130, v130
    v_dot2c_f32_bf16 v14, v131, v69
    v_dot2c_f32_bf16 v15, v131, v131
    s_waitcnt lgkmcnt(5)
    v_dot2c_f32_bf16 v14, v136, v69
    v_dot2c_f32_bf16 v15, v136, v136
    v_dot2c_f32_bf16 v14, v137, v69
    v_dot2c_f32_bf16 v15, v137, v137
    v_dot2c_f32_bf16 v14, v138, v69
    v_dot2c_f32_bf16 v15, v138, v138
    v_dot2c_f32_bf16 v14, v139, v69
    v_dot2c_f32_bf16 v15, v139, v139
    s_waitcnt lgkmcnt(4)
    v_dot2c_f32_bf16 v14, v144, v69
    v_dot2c_f32_bf16 v15, v144, v144
    v_dot2c_f32_bf16 v14, v145, v69
    v_dot2c_f32_bf16 v15, v145, v145
    v_dot2c_f32_bf16 v14, v146, v69
    v_dot2c_f32_bf16 v15, v146, v146
    v_dot2c_f32_bf16 v14, v147, v69
    v_dot2c_f32_bf16 v15, v147, v147
    s_barrier
    ds_read_b128 v[152:155], v72 offset:16384
    ds_read_b128 v[160:163], v74 offset:16384
    ds_read_b128 v[168:171], v76 offset:16384
    ds_read_b128 v[176:179], v78 offset:16384
    ds_read_b128 v[156:159], v73 offset:16384
    ds_read_b128 v[164:167], v75 offset:16384
    ds_read_b128 v[172:175], v77 offset:16384
    ds_read_b128 v[180:183], v79 offset:16384
    s_waitcnt lgkmcnt(7)
    v_dot2c_f32_bf16 v14, v152, v69
    v_dot2c_f32_bf16 v15, v152, v152
    v_dot2c_f32_bf16 v14, v153, v69
    v_dot2c_f32_bf16 v15, v153, v153
    v_dot2c_f32_bf16 v14, v154, v69
    v_dot2c_f32_bf16 v15, v154, v154
    v_dot2c_f32_bf16 v14, v155, v69
    v_dot2c_f32_bf16 v15, v155, v155
    s_waitcnt lgkmcnt(6)
    v_dot2c_f32_bf16 v14, v160, v69
    v_dot2c_f32_bf16 v15, v160, v160
    v_dot2c_f32_bf16 v14, v161, v69
    v_dot2c_f32_bf16 v15, v161, v161
    v_dot2c_f32_bf16 v14, v162, v69
    v_dot2c_f32_bf16 v15, v162, v162
    v_dot2c_f32_bf16 v14, v163, v69
    v_dot2c_f32_bf16 v15, v163, v163
    s_waitcnt lgkmcnt(5)
    v_dot2c_f32_bf16 v14, v168, v69
    v_dot2c_f32_bf16 v15, v168, v168
    v_dot2c_f32_bf16 v14, v169, v69
    v_dot2c_f32_bf16 v15, v169, v169
    v_dot2c_f32_bf16 v14, v170, v69
    v_dot2c_f32_bf16 v15, v170, v170
    v_dot2c_f32_bf16 v14, v171, v69
    v_dot2c_f32_bf16 v15, v171, v171
    s_waitcnt lgkmcnt(4)
    v_dot2c_f32_bf16 v14, v176, v69
    v_dot2c_f32_bf16 v15, v176, v176
    v_dot2c_f32_bf16 v14, v177, v69
    v_dot2c_f32_bf16 v15, v177, v177
    v_dot2c_f32_bf16 v14, v178, v69
    v_dot2c_f32_bf16 v15, v178, v178
    v_dot2c_f32_bf16 v14, v179, v69
    v_dot2c_f32_bf16 v15, v179, v179
    s_barrier
    ds_read_b128 v[184:187], v72 offset:32768
    ds_read_b128 v[192:195], v74 offset:32768
    ds_read_b128 v[200:203], v76 offset:32768
    ds_read_b128 v[208:211], v78 offset:32768
    ds_read_b128 v[188:191], v73 offset:32768
    ds_read_b128 v[196:199], v75 offset:32768
    ds_read_b128 v[204:207], v77 offset:32768
    ds_read_b128 v[212:215], v79 offset:32768
    s_waitcnt lgkmcnt(7)
    v_dot2c_f32_bf16 v14, v184, v69
    v_dot2c_f32_bf16 v15, v184, v184
    v_dot2c_f32_bf16 v14, v185, v69
    v_dot2c_f32_bf16 v15, v185, v185
    v_dot2c_f32_bf16 v14, v186, v69
    v_dot2c_f32_bf16 v15, v186, v186
    v_dot2c_f32_bf16 v14, v187, v69
    v_dot2c_f32_bf16 v15, v187, v187
    s_waitcnt lgkmcnt(6)
    v_dot2c_f32_bf16 v14, v192, v69
    v_dot2c_f32_bf16 v15, v192, v192
    v_dot2c_f32_bf16 v14, v193, v69
    v_dot2c_f32_bf16 v15, v193, v193
    v_dot2c_f32_bf16 v14, v194, v69
    v_dot2c_f32_bf16 v15, v194, v194
    v_dot2c_f32_bf16 v14, v195, v69
    v_dot2c_f32_bf16 v15, v195, v195
    s_waitcnt lgkmcnt(5)
    v_dot2c_f32_bf16 v14, v200, v69
    v_dot2c_f32_bf16 v15, v200, v200
    v_dot2c_f32_bf16 v14, v201, v69
    v_dot2c_f32_bf16 v15, v201, v201
    v_dot2c_f32_bf16 v14, v202, v69
    v_dot2c_f32_bf16 v15, v202, v202
    v_dot2c_f32_bf16 v14, v203, v69
    v_dot2c_f32_bf16 v15, v203, v203
    s_waitcnt lgkmcnt(4)
    v_dot2c_f32_bf16 v14, v208, v69
    v_dot2c_f32_bf16 v15, v208, v208
    v_dot2c_f32_bf16 v14, v209, v69
    v_dot2c_f32_bf16 v15, v209, v209
    v_dot2c_f32_bf16 v14, v210, v69
    v_dot2c_f32_bf16 v15, v210, v210
    v_dot2c_f32_bf16 v14, v211, v69
    v_dot2c_f32_bf16 v15, v211, v211
    s_waitcnt vmcnt(0)
    v_lshl_or_b32 v80, v81, 16, v80
    v_lshl_or_b32 v81, v83, 16, v82
    v_lshl_or_b32 v82, v85, 16, v84
    v_lshl_or_b32 v83, v87, 16, v86
    buffer_store_dwordx4 v[80:83], v13, s[36:39], s59 offen sc0 sc1
    s_barrier
    ds_read_b128 v[216:219], v72 offset:49152
    ds_read_b128 v[224:227], v74 offset:49152
    ds_read_b128 v[232:235], v76 offset:49152
    ds_read_b128 v[240:243], v78 offset:49152
    ds_read_b128 v[220:223], v73 offset:49152
    ds_read_b128 v[228:231], v75 offset:49152
    ds_read_b128 v[236:239], v77 offset:49152
    ds_read_b128 v[244:247], v79 offset:49152
    s_waitcnt lgkmcnt(7)
    v_dot2c_f32_bf16 v14, v216, v69
    v_dot2c_f32_bf16 v15, v216, v216
    v_dot2c_f32_bf16 v14, v217, v69
    v_dot2c_f32_bf16 v15, v217, v217
    v_dot2c_f32_bf16 v14, v218, v69
    v_dot2c_f32_bf16 v15, v218, v218
    v_dot2c_f32_bf16 v14, v219, v69
    v_dot2c_f32_bf16 v15, v219, v219
    s_waitcnt lgkmcnt(6)
    v_dot2c_f32_bf16 v14, v224, v69
    v_dot2c_f32_bf16 v15, v224, v224
    v_dot2c_f32_bf16 v14, v225, v69
    v_dot2c_f32_bf16 v15, v225, v225
    v_dot2c_f32_bf16 v14, v226, v69
    v_dot2c_f32_bf16 v15, v226, v226
    v_dot2c_f32_bf16 v14, v227, v69
    v_dot2c_f32_bf16 v15, v227, v227
    s_waitcnt lgkmcnt(5)
    v_dot2c_f32_bf16 v14, v232, v69
    v_dot2c_f32_bf16 v15, v232, v232
    v_dot2c_f32_bf16 v14, v233, v69
    v_dot2c_f32_bf16 v15, v233, v233
    v_dot2c_f32_bf16 v14, v234, v69
    v_dot2c_f32_bf16 v15, v234, v234
    v_dot2c_f32_bf16 v14, v235, v69
    v_dot2c_f32_bf16 v15, v235, v235
    s_waitcnt lgkmcnt(4)
    v_dot2c_f32_bf16 v14, v240, v69
    v_dot2c_f32_bf16 v15, v240, v240
    v_dot2c_f32_bf16 v14, v241, v69
    v_dot2c_f32_bf16 v15, v241, v241
    v_dot2c_f32_bf16 v14, v242, v69
    v_dot2c_f32_bf16 v15, v242, v242
    v_dot2c_f32_bf16 v14, v243, v69
    v_dot2c_f32_bf16 v15, v243, v243
    v_mov_b32 v7, 154624
    s_nop 1
    v_permlane32_swap_b32 v14, v15
    ds_write_b32 v7, v90 offset:8
    v_add_f32 v14, v14, v15
    ds_write_b32 v65, v14
    v_mov_b32 v15, 0
    s_waitcnt lgkmcnt(0)
    s_barrier
    ds_read_b64_tr_b16 v[32:33], v68 offset:0
    ds_read_b64_tr_b16 v[34:35], v68 offset:512
    ds_read_b64_tr_b16 v[36:37], v70 offset:0
    ds_read_b64_tr_b16 v[38:39], v70 offset:512
    ds_read_b64_tr_b16 v[40:41], v68 offset:4096
    ds_read_b64_tr_b16 v[42:43], v68 offset:4608
    ds_read_b64_tr_b16 v[44:45], v70 offset:4096
    ds_read_b64_tr_b16 v[46:47], v70 offset:4608
    ds_read_b64_tr_b16 v[48:49], v68 offset:8192
    ds_read_b64_tr_b16 v[50:51], v68 offset:8704
    ds_read_b64_tr_b16 v[52:53], v70 offset:8192
    ds_read_b64_tr_b16 v[54:55], v70 offset:8704
    ds_read_b64_tr_b16 v[56:57], v68 offset:12288
    ds_read_b64_tr_b16 v[58:59], v68 offset:12800
    s_waitcnt lgkmcnt(12)
    ds_read_b64_tr_b16 v[60:61], v70 offset:12288
    ds_read_b64_tr_b16 v[62:63], v70 offset:12800
    s_waitcnt lgkmcnt(8)
    v_dot2c_f32_bf16 v15, v32, v69
    v_dot2c_f32_bf16 v15, v33, v69
    v_dot2c_f32_bf16 v15, v34, v69
    v_dot2c_f32_bf16 v15, v35, v69
    v_dot2c_f32_bf16 v15, v36, v69
    v_dot2c_f32_bf16 v15, v37, v69
    v_dot2c_f32_bf16 v15, v38, v69
    v_dot2c_f32_bf16 v15, v39, v69
    v_dot2c_f32_bf16 v15, v40, v69
    v_dot2c_f32_bf16 v15, v41, v69
    v_dot2c_f32_bf16 v15, v42, v69
    v_dot2c_f32_bf16 v15, v43, v69
    v_dot2c_f32_bf16 v15, v44, v69
    v_dot2c_f32_bf16 v15, v45, v69
    v_dot2c_f32_bf16 v15, v46, v69
    v_dot2c_f32_bf16 v15, v47, v69
    v_mfma_f32_32x32x16_bf16 v[16:31], v[32:35], v[120:123], 0
    v_mfma_f32_32x32x16_bf16 v[16:31], v[36:39], v[124:127], v[16:31]
    v_mfma_f32_32x32x16_bf16 v[16:31], v[40:43], v[128:131], v[16:31]
    v_mfma_f32_32x32x16_bf16 v[16:31], v[44:47], v[132:135], v[16:31]
    s_waitcnt lgkmcnt(0)
    v_dot2c_f32_bf16 v15, v48, v69
    v_dot2c_f32_bf16 v15, v49, v69
    v_dot2c_f32_bf16 v15, v50, v69
    v_dot2c_f32_bf16 v15, v51, v69
    v_dot2c_f32_bf16 v15, v52, v69
    v_dot2c_f32_bf16 v15, v53, v69
    v_dot2c_f32_bf16 v15, v54, v69
    v_dot2c_f32_bf16 v15, v55, v69
    v_dot2c_f32_bf16 v15, v56, v69
    v_dot2c_f32_bf16 v15, v57, v69
    v_dot2c_f32_bf16 v15, v58, v69
    v_dot2c_f32_bf16 v15, v59, v69
    v_dot2c_f32_bf16 v15, v60, v69
    v_dot2c_f32_bf16 v15, v61, v69
    v_dot2c_f32_bf16 v15, v62, v69
    v_dot2c_f32_bf16 v15, v63, v69
    v_mfma_f32_32x32x16_bf16 v[16:31], v[48:51], v[136:139], v[16:31]
    v_mfma_f32_32x32x16_bf16 v[16:31], v[52:55], v[140:143], v[16:31]
    v_mfma_f32_32x32x16_bf16 v[16:31], v[56:59], v[144:147], v[16:31]
    v_mfma_f32_32x32x16_bf16 v[16:31], v[60:63], v[148:151], v[16:31]
    s_barrier
    ds_read_b64_tr_b16 v[32:33], v68 offset:16384
    ds_read_b64_tr_b16 v[34:35], v68 offset:16896
    ds_read_b64_tr_b16 v[36:37], v70 offset:16384
    ds_read_b64_tr_b16 v[38:39], v70 offset:16896
    ds_read_b64_tr_b16 v[40:41], v68 offset:20480
    ds_read_b64_tr_b16 v[42:43], v68 offset:20992
    ds_read_b64_tr_b16 v[44:45], v70 offset:20480
    ds_read_b64_tr_b16 v[46:47], v70 offset:20992
    ds_read_b64_tr_b16 v[48:49], v68 offset:24576
    ds_read_b64_tr_b16 v[50:51], v68 offset:25088
    ds_read_b64_tr_b16 v[52:53], v70 offset:24576
    ds_read_b64_tr_b16 v[54:55], v70 offset:25088
    ds_read_b64_tr_b16 v[56:57], v68 offset:28672
    ds_read_b64_tr_b16 v[58:59], v68 offset:29184
    s_waitcnt lgkmcnt(12)
    ds_read_b64_tr_b16 v[60:61], v70 offset:28672
    ds_read_b64_tr_b16 v[62:63], v70 offset:29184
    s_waitcnt lgkmcnt(8)
    v_dot2c_f32_bf16 v15, v32, v69
    v_dot2c_f32_bf16 v15, v33, v69
    v_dot2c_f32_bf16 v15, v34, v69
    v_dot2c_f32_bf16 v15, v35, v69
    v_dot2c_f32_bf16 v15, v36, v69
    v_dot2c_f32_bf16 v15, v37, v69
    v_dot2c_f32_bf16 v15, v38, v69
    v_dot2c_f32_bf16 v15, v39, v69
    v_dot2c_f32_bf16 v15, v40, v69
    v_dot2c_f32_bf16 v15, v41, v69
    v_dot2c_f32_bf16 v15, v42, v69
    v_dot2c_f32_bf16 v15, v43, v69
    v_dot2c_f32_bf16 v15, v44, v69
    v_dot2c_f32_bf16 v15, v45, v69
    v_dot2c_f32_bf16 v15, v46, v69
    v_dot2c_f32_bf16 v15, v47, v69
    s_waitcnt vmcnt(0)
    s_barrier
    ds_read_b128 v[84:87], v67
    v_mfma_f32_32x32x16_bf16 v[16:31], v[32:35], v[152:155], v[16:31]
    ds_read_b64_tr_b16 v[32:33], v68 offset:32768
    ds_read_b64_tr_b16 v[34:35], v68 offset:33280
    v_mfma_f32_32x32x16_bf16 v[16:31], v[36:39], v[156:159], v[16:31]
    ds_read_b64_tr_b16 v[36:37], v70 offset:32768
    ds_read_b64_tr_b16 v[38:39], v70 offset:33280
    v_mfma_f32_32x32x16_bf16 v[16:31], v[40:43], v[160:163], v[16:31]
    ds_read_b64_tr_b16 v[40:41], v68 offset:36864
    ds_read_b64_tr_b16 v[42:43], v68 offset:37376
    v_mfma_f32_32x32x16_bf16 v[16:31], v[44:47], v[164:167], v[16:31]
    ds_read_b64_tr_b16 v[44:45], v70 offset:36864
    ds_read_b64_tr_b16 v[46:47], v70 offset:37376
    s_waitcnt lgkmcnt(8)
    v_dot2c_f32_bf16 v15, v48, v69
    v_dot2c_f32_bf16 v15, v49, v69
    v_dot2c_f32_bf16 v15, v50, v69
    v_dot2c_f32_bf16 v15, v51, v69
    v_dot2c_f32_bf16 v15, v52, v69
    v_dot2c_f32_bf16 v15, v53, v69
    v_dot2c_f32_bf16 v15, v54, v69
    v_dot2c_f32_bf16 v15, v55, v69
    v_dot2c_f32_bf16 v15, v56, v69
    v_dot2c_f32_bf16 v15, v57, v69
    v_dot2c_f32_bf16 v15, v58, v69
    v_dot2c_f32_bf16 v15, v59, v69
    v_dot2c_f32_bf16 v15, v60, v69
    v_dot2c_f32_bf16 v15, v61, v69
    v_dot2c_f32_bf16 v15, v62, v69
    v_dot2c_f32_bf16 v15, v63, v69
    v_mfma_f32_32x32x16_bf16 v[16:31], v[48:51], v[168:171], v[16:31]
    ds_read_b64_tr_b16 v[48:49], v68 offset:40960
    ds_read_b64_tr_b16 v[50:51], v68 offset:41472
    v_mfma_f32_32x32x16_bf16 v[16:31], v[52:55], v[172:175], v[16:31]
    ds_read_b64_tr_b16 v[52:53], v70 offset:40960
    ds_read_b64_tr_b16 v[54:55], v70 offset:41472
    v_mfma_f32_32x32x16_bf16 v[16:31], v[56:59], v[176:179], v[16:31]
    ds_read_b64_tr_b16 v[56:57], v68 offset:45056
    ds_read_b64_tr_b16 v[58:59], v68 offset:45568
    v_mfma_f32_32x32x16_bf16 v[16:31], v[60:63], v[180:183], v[16:31]
    ds_read_b64_tr_b16 v[60:61], v70 offset:45056
    ds_read_b64_tr_b16 v[62:63], v70 offset:45568
    s_waitcnt lgkmcnt(8)
    v_dot2c_f32_bf16 v15, v32, v69
    v_dot2c_f32_bf16 v15, v33, v69
    v_dot2c_f32_bf16 v15, v34, v69
    v_dot2c_f32_bf16 v15, v35, v69
    v_dot2c_f32_bf16 v15, v36, v69
    v_dot2c_f32_bf16 v15, v37, v69
    v_dot2c_f32_bf16 v15, v38, v69
    v_dot2c_f32_bf16 v15, v39, v69
    v_dot2c_f32_bf16 v15, v40, v69
    v_dot2c_f32_bf16 v15, v41, v69
    v_dot2c_f32_bf16 v15, v42, v69
    v_dot2c_f32_bf16 v15, v43, v69
    v_dot2c_f32_bf16 v15, v44, v69
    v_dot2c_f32_bf16 v15, v45, v69
    v_dot2c_f32_bf16 v15, v46, v69
    v_dot2c_f32_bf16 v15, v47, v69
    s_barrier
    ds_read_b32 v66, v7
    v_mfma_f32_32x32x16_bf16 v[16:31], v[32:35], v[184:187], v[16:31]
    ds_read_b64_tr_b16 v[32:33], v68 offset:49152
    ds_read_b64_tr_b16 v[34:35], v68 offset:49664
    v_add_f32 v8, v84, v86
    v_add_f32 v9, v85, v87
    v_mul_f32 v8, 0xbb000000, v8
    v_mul_f32 v9, 0x3b000000, v9
    v_fma_f32 v9, -v8, v8, v9
    v_max_f32 v9, 0, v9
    v_cvt_pk_bf16_f32 v9, v8, v9
    v_lshlrev_b32 v8, 16, v9
    v_and_b32 v9, 0xffff0000, v9
    v_add_f32 v9, 0x3727c5ac, v9
    v_cvt_pk_bf16_f32 v9, v9, v9
    v_and_b32 v9, 0xffff0000, v9
    v_sqrt_f32 v9, v9
    s_nop 0
    v_cvt_pk_bf16_f32 v9, v9, v9
    v_and_b32 v9, 0xffff0000, v9
    v_rcp_f32 v9, v9
    v_mfma_f32_32x32x16_bf16 v[16:31], v[36:39], v[188:191], v[16:31]
    ds_read_b64_tr_b16 v[36:37], v70 offset:49152
    ds_read_b64_tr_b16 v[38:39], v70 offset:49664
    v_and_b32 v11, 0xffff0000, v8
    v_sub_f32 v12, v8, v11
    v_cvt_pk_bf16_f32 v88, v11, v12
    v_cvt_pk_bf16_f32 v89, v11, 0
    v_mul_f32 v10, 0x3eb8aa3b, v9
    v_mfma_f32_32x32x16_bf16 v[16:31], v[40:43], v[192:195], v[16:31]
    ds_read_b64_tr_b16 v[40:41], v68 offset:53248
    ds_read_b64_tr_b16 v[42:43], v68 offset:53760
    v_mfma_f32_32x32x16_bf16 v[16:31], v[44:47], v[196:199], v[16:31]
    ds_read_b64_tr_b16 v[44:45], v70 offset:53248
    ds_read_b64_tr_b16 v[46:47], v70 offset:53760
    s_waitcnt lgkmcnt(8)
    v_dot2c_f32_bf16 v15, v48, v69
    v_dot2c_f32_bf16 v15, v49, v69
    v_dot2c_f32_bf16 v15, v50, v69
    v_dot2c_f32_bf16 v15, v51, v69
    v_dot2c_f32_bf16 v15, v52, v69
    v_dot2c_f32_bf16 v15, v53, v69
    v_dot2c_f32_bf16 v15, v54, v69
    v_dot2c_f32_bf16 v15, v55, v69
    v_dot2c_f32_bf16 v15, v56, v69
    v_dot2c_f32_bf16 v15, v57, v69
    v_dot2c_f32_bf16 v15, v58, v69
    v_dot2c_f32_bf16 v15, v59, v69
    v_dot2c_f32_bf16 v15, v60, v69
    v_dot2c_f32_bf16 v15, v61, v69
    v_dot2c_f32_bf16 v15, v62, v69
    v_dot2c_f32_bf16 v15, v63, v69
    v_mfma_f32_32x32x16_bf16 v[16:31], v[48:51], v[200:203], v[16:31]
    ds_read_b64_tr_b16 v[48:49], v68 offset:57344
    ds_read_b64_tr_b16 v[50:51], v68 offset:57856
    v_mfma_f32_32x32x16_bf16 v[16:31], v[52:55], v[204:207], v[16:31]
    ds_read_b64_tr_b16 v[52:53], v70 offset:57344
    ds_read_b64_tr_b16 v[54:55], v70 offset:57856
    v_mfma_f32_32x32x16_bf16 v[16:31], v[56:59], v[208:211], v[16:31]
    ds_read_b64_tr_b16 v[56:57], v68 offset:61440
    ds_read_b64_tr_b16 v[58:59], v68 offset:61952
    v_mfma_f32_32x32x16_bf16 v[16:31], v[60:63], v[212:215], v[16:31]
    ds_read_b64_tr_b16 v[60:61], v70 offset:61440
    ds_read_b64_tr_b16 v[62:63], v70 offset:61952
    s_waitcnt lgkmcnt(8)
    v_dot2c_f32_bf16 v15, v32, v69
    v_dot2c_f32_bf16 v15, v33, v69
    v_dot2c_f32_bf16 v15, v34, v69
    v_dot2c_f32_bf16 v15, v35, v69
    v_dot2c_f32_bf16 v15, v36, v69
    v_dot2c_f32_bf16 v15, v37, v69
    v_dot2c_f32_bf16 v15, v38, v69
    v_dot2c_f32_bf16 v15, v39, v69
    v_dot2c_f32_bf16 v15, v40, v69
    v_dot2c_f32_bf16 v15, v41, v69
    v_dot2c_f32_bf16 v15, v42, v69
    v_dot2c_f32_bf16 v15, v43, v69
    v_dot2c_f32_bf16 v15, v44, v69
    v_dot2c_f32_bf16 v15, v45, v69
    v_dot2c_f32_bf16 v15, v46, v69
    v_dot2c_f32_bf16 v15, v47, v69
    v_readfirstlane_b32 s68, v66
    v_mfma_f32_32x32x16_bf16 v[16:31], v[32:35], v[216:219], v[16:31]
    v_mfma_f32_32x32x16_bf16 v[16:31], v[36:39], v[220:223], v[16:31]
    v_mfma_f32_32x32x16_bf16 v[16:31], v[40:43], v[224:227], v[16:31]
    v_mfma_f32_32x32x16_bf16 v[16:31], v[44:47], v[228:231], v[16:31]
    s_waitcnt lgkmcnt(0)
    v_dot2c_f32_bf16 v15, v48, v69
    v_dot2c_f32_bf16 v15, v49, v69
    v_dot2c_f32_bf16 v15, v50, v69
    v_dot2c_f32_bf16 v15, v51, v69
    v_dot2c_f32_bf16 v15, v52, v69
    v_dot2c_f32_bf16 v15, v53, v69
    v_dot2c_f32_bf16 v15, v54, v69
    v_dot2c_f32_bf16 v15, v55, v69
    v_dot2c_f32_bf16 v15, v56, v69
    v_dot2c_f32_bf16 v15, v57, v69
    v_dot2c_f32_bf16 v15, v58, v69
    v_dot2c_f32_bf16 v15, v59, v69
    v_dot2c_f32_bf16 v15, v60, v69
    v_dot2c_f32_bf16 v15, v61, v69
    v_dot2c_f32_bf16 v15, v62, v69
    v_dot2c_f32_bf16 v15, v63, v69
    v_mfma_f32_32x32x16_bf16 v[16:31], v[48:51], v[232:235], v[16:31]
    v_mfma_f32_32x32x16_bf16 v[16:31], v[52:55], v[236:239], v[16:31]
    s_nop 0
    v_and_b32 v11, 0xffff0000, v15
    v_sub_f32 v12, v15, v11
    v_cvt_pk_bf16_f32 v248, v11, v11
    v_cvt_pk_bf16_f32 v249, v12, 0
    v_mfma_f32_32x32x16_bf16 v[16:31], v[56:59], v[240:243], v[16:31]
    v_mfma_f32_32x32x16_bf16 v[16:31], v[60:63], v[244:247], v[16:31]
    v_mfma_f32_32x32x16_bf16 v[16:31], v[248:251], v[88:91], v[16:31]
    v_mov_b32 v35, v66
    v_mov_b32 v39, v66
    v_mov_b32 v43, v66
    v_lshrrev_b32 v44, 3, v5
    v_lshlrev_b32 v44, 12, v44
    v_and_b32 v11, 7, v5
    v_lshl_add_u32 v44, v11, 4, v44
    v_lshl_add_u32 v44, v6, 8, v44
    s_sub_u32 s61, s60, 0
    s_lshr_b32 s61, s61, 1
    s_add_u32 s61, s61, 7340032
    s_nop 0
    v_mul_f32 v16, v10, v16
    v_mul_f32 v17, v10, v17
    v_cvt_pk_bf16_f32 v32, v16, v17
    v_mul_f32 v18, v10, v18
    v_mul_f32 v19, v10, v19
    v_cvt_pk_bf16_f32 v33, v18, v19
    v_mul_f32 v20, v10, v20
    v_mul_f32 v21, v10, v21
    v_cvt_pk_bf16_f32 v34, v20, v21
    buffer_store_dwordx4 v[32:35], v64, s[36:39], s60 offen sc0 sc1
    v_mul_f32 v22, v10, v22
    v_mul_f32 v23, v10, v23
    v_cvt_pk_bf16_f32 v36, v22, v23
    v_mul_f32 v24, v10, v24
    v_mul_f32 v25, v10, v25
    v_cvt_pk_bf16_f32 v40, v24, v25
    v_mul_f32 v26, v10, v26
    v_mul_f32 v27, v10, v27
    v_cvt_pk_bf16_f32 v41, v26, v27
    v_mul_f32 v28, v10, v28
    v_mul_f32 v29, v10, v29
    v_cvt_pk_bf16_f32 v42, v28, v29
    buffer_store_dwordx4 v[40:43], v64, s[36:39], s60 offen offset:128 sc0 sc1
    v_mul_f32 v30, v10, v30
    v_mul_f32 v31, v10, v31
    v_cvt_pk_bf16_f32 v37, v30, v31
    buffer_store_dwordx4 v[36:39], v44, s[36:39], s61 offen sc0 sc1
L2_start:
    s_setprio 0
    s_load_dwordx8 s[52:59], s[0:1], 48
    s_load_dwordx2 s[8:9], s[0:1], 80
    v_lshlrev_b32 v103, 4, v2
    v_and_b32 v5, 31, v2
    v_lshrrev_b32 v6, 5, v2
    s_lshl_b32 s41, s41, 3
    s_add_u32 s41, s41, s42
    s_lshl_b32 s44, s41, 13
    s_lshl_b32 s45, s40, 10
    s_add_u32 s46, s44, s45
    s_add_u32 s47, s45, 2097152
    s_lshl_b32 s50, s40, 16
    s_add_u32 s51, s50, 3145728
    s_and_b32 s48, s40, 4
    s_lshl_b32 s48, s48, 13
    s_add_u32 s50, s51, s48
    s_mov_b32 s28, s14
    s_and_b32 s29, s15, 0xffff
    s_mov_b32 s30, 8388608
    s_mov_b32 s31, 0x20000
    s_waitcnt lgkmcnt(0)
    s_mov_b32 s16, s4
    s_and_b32 s17, s5, 0xffff
    s_mov_b32 s18, 2097152
    s_mov_b32 s19, 0x20000
    s_mov_b32 s20, s52
    s_and_b32 s21, s53, 0xffff
    s_mov_b32 s22, 1024
    s_mov_b32 s23, 0x20000
    s_mov_b32 s24, s8
    s_and_b32 s25, s9, 0xffff
    s_mov_b32 s26, 2097152
    s_mov_b32 s27, 0x20000
    v_lshlrev_b32 v3, 8, v6
    v_lshl_add_u32 v3, v5, 4, v3
    v_and_b32 v4, 27, v5
    v_cmp_eq_u32 vcc, 16, v4
    v_mov_b32 v4, 528
    v_mov_b32 v7, 512
    v_cndmask_b32 v4, v4, v7, vcc
    v_cmp_gt_u32 vcc, 16, v5
    v_mov_b32 v101, v103
    v_mov_b32 v100, 0xdddddddd
    v_cndmask_b32 v3, v4, v3, vcc
    v_add_u32 v107, 1024, v3
    v_mov_b32 v102, v107
    v_and_b32 v3, 12, v2
    v_lshlrev_b32 v3, 2, v3
    v_lshl_add_u32 v3, v6, 6, v3
    s_lshl_b32 s49, s40, 7
    v_add_u32 v105, s49, v3
    v_and_b32 v4, 16, v2
    v_lshlrev_b32 v4, 8, v4
    v_and_b32 v3, 15, v2
    v_lshl_add_u32 v0, v3, 2, v4
    v_lshl_add_u32 v0, v6, 6, v0
    v_add_u32 v0, s49, v0
    v_and_b32 v3, 3, v2
    v_lshl_add_u32 v4, v3, 10, v4
    v_add_u32 v104, v4, v105
    s_and_b32 s48, s2, 7
    s_lshr_b32 s49, s2, 3
    s_mul_i32 s64, s48, 22
    s_add_u32 s64, s64, s49
    s_lshl_b32 s48, s48, 3
    s_add_u32 s48, s48, s49
    s_sub_u32 s61, s48, 22
    s_and_b32 s61, s61, 63
    s_lshl_b32 s61, s61, 4
    s_min_u32 s48, s64, 171
    s_lshl_b32 s48, s48, 4
    s_mul_i32 s49, s40, 176128
    s_add_u32 s48, s48, s49
    s_lshl_b32 s49, s40, 16
    s_add_u32 s49, s49, s61
    s_add_u32 s66, s49, 524288
    s_add_u32 s67, s49, 1048576
    s_movk_i32 s60, 2752
    s_cmp_ge_u32 s2, 176
    s_cselect_b32 s65, s49, s48
    s_cselect_b32 s66, s66, s48
    s_cselect_b32 s67, s67, 0x200000
    s_cselect_b32 s60, 0x400, s60
    s_cselect_b32 s54, s58, s54
    s_cselect_b32 s55, s59, s55
    s_cselect_b32 s56, s58, s56
    s_cselect_b32 s57, s59, s57
    v_mul_u32_u24 v1, s60, v2
    s_mov_b32 s32, s54
    s_and_b32 s33, s55, 0xffff
    s_mov_b32 s34, 1409024
    s_mov_b32 s35, 0x20000
    s_mov_b32 s36, s56
    s_and_b32 s37, s57, 0xffff
    s_mov_b32 s38, 1409024
    s_mov_b32 s39, 0x20000
    s_mov_b32 s4, s58
    s_and_b32 s5, s59, 0xffff
    s_mov_b32 s6, 1409024
    s_mov_b32 s7, 0x20000
    s_lshr_b32 s11, s2, 3
    s_lshl_b32 s11, s11, 3
    s_add_u32 s11, s11, s40
    s_lshl_b32 s11, s11, 13
    s_and_b32 s48, s2, 7
    s_lshl_b32 s48, s48, 7
    s_add_u32 s11, s11, s48
    v_lshrrev_b32 v3, 3, v2
    v_and_b32 v4, 7, v2
    v_lshlrev_b32 v4, 4, v4
    v_lshl_add_u32 v244, v3, 10, v4
    s_mov_b32 s60, 131072
    s_cmp_lt_u32 s40, 4
    s_cselect_b32 s60, s60, 8388608
    v_mov_b32 v3, 160896
    v_mov_b32 v84, 0
    v_mov_b32 v85, 0
    v_mov_b32 v86, 0
    v_mov_b32 v87, 0
    v_mov_b32 v88, 0
    v_mov_b32 v89, 0
    v_mov_b32 v90, 0
    v_mov_b32 v91, 0
    v_mov_b32 v92, 0
    v_mov_b32 v93, 0
    v_mov_b32 v94, 0
    v_mov_b32 v95, 0
    v_mov_b32 v96, 0
    v_mov_b32 v97, 0
    v_mov_b32 v98, 0
    v_mov_b32 v99, 0
    ds_write_b32 v3, v84
    ds_write_b128 v3, v[84:87] offset:16
    s_lshr_b32 s12, s46, 1
    s_add_u32 s12, s12, 7340032
    s_add_u32 s46, s46, 0
    v_lshrrev_b32 v7, 4, v2
    v_lshlrev_b32 v7, 7, v7
    v_and_b32 v4, 7, v2
    v_lshl_add_u32 v7, v4, 4, v7
    s_cmp_lt_u32 s40, 4
    s_cbranch_scc1 L2_noflag
    s_sub_u32 s13, s40, 4
    s_lshl_b32 s48, s13, 10
    s_add_u32 s48, s48, 6553600
    v_lshlrev_b32 v3, 4, v2
    s_mov_b32 s49, 0
L2_fpoll:
    buffer_load_dword v4, v3, s[28:31], s48 offen sc1
    s_add_u32 s49, s49, 1
    s_waitcnt vmcnt(0)
    v_cmp_ne_u32 vcc, s68, v4
    s_cmp_gt_u32 s49, 0x40000
    s_cbranch_scc1 L2_fgot
    s_and_b64 exec, exec, vcc
    s_cbranch_scc0 L2_fgot
    s_branch L2_fpoll
L2_fgot:
    s_mov_b64 exec, 1
    v_mov_b32 v3, 154632
    v_mov_b32 v4, 1
    ds_add_u32 v3, v4
L2_fspin:
    ds_read_b32 v4, v3
    s_waitcnt lgkmcnt(0)
    v_readfirstlane_b32 s49, v4
    s_cmp_lt_u32 s49, 4
    s_cbranch_scc1 L2_fspin
    s_mov_b64 exec, -1
    s_lshl_b32 s13, s13, 10
    s_add_u32 s62, s13, 2097152
    s_add_u32 m0, s13, 0
    s_add_u32 s48, s62, 0
    buffer_load_dwordx4 v103, s[28:31], s48 offen sc1 lds
    s_add_u32 m0, s13, 4096
    s_add_u32 s48, s62, 4096
    buffer_load_dwordx4 v103, s[28:31], s48 offen sc1 lds
    s_add_u32 m0, s13, 8192
    s_add_u32 s48, s62, 8192
    buffer_load_dwordx4 v103, s[28:31], s48 offen sc1 lds
    s_add_u32 m0, s13, 12288
    s_add_u32 s48, s62, 12288
    buffer_load_dwordx4 v103, s[28:31], s48 offen sc1 lds
    s_add_u32 m0, s13, 16384
    s_add_u32 s48, s62, 16384
    buffer_load_dwordx4 v103, s[28:31], s48 offen sc1 lds
    s_add_u32 m0, s13, 20480
    s_add_u32 s48, s62, 20480
    buffer_load_dwordx4 v103, s[28:31], s48 offen sc1 lds
L2_noflag:
    s_barrier
    s_mov_b32 s49, 0
L2_qpoll:
    buffer_load_dwordx4 v[8:11], v103, s[28:31], s46 offen sc1
    buffer_load_dwordx4 v[52:55], v7, s[28:31], s12 offen sc1
    s_add_u32 s49, s49, 1
    s_waitcnt vmcnt(0)
    v_cmp_ne_u32 vcc, s68, v11
    v_cmp_ne_u32 s[62:63], s68, v55
    s_cmp_gt_u32 s49, 0x40000
    s_cbranch_scc1 L2_qgot
    s_or_b64 exec, vcc, s[62:63]
    s_cbranch_scc1 L2_qpoll
L2_qgot:
    s_mov_b64 exec, -1
    s_mov_b32 s62, 0xff00ff00
    s_mov_b32 s63, s62
    v_cndmask_b32 v11, v52, v53, s[62:63]
    s_waitcnt lgkmcnt(0)
    s_barrier
    ds_read_b128 v[28:31], v101
    ds_read_b128 v[32:35], v101 offset:2112
    ds_read_b128 v[36:39], v102
    ds_read_b128 v[40:43], v102 offset:544
    s_waitcnt lgkmcnt(3)
    v_mfma_f32_32x32x16_bf16 v[52:67], v[28:31], v[8:11], 0
    s_waitcnt lgkmcnt(2)
    v_mfma_f32_32x32x16_bf16 v[68:83], v[32:35], v[8:11], 0
    s_nop 9
    v_max3_f32 v106, v52, v53, v54
    v_max3_f32 v106, v55, v56, v106
    v_max3_f32 v106, v57, v58, v106
    v_max3_f32 v106, v59, v60, v106
    v_max3_f32 v106, v61, v62, v106
    v_max3_f32 v106, v63, v64, v106
    v_max3_f32 v106, v65, v66, v106
    v_max3_f32 v106, v67, v68, v106
    v_max3_f32 v106, v69, v70, v106
    v_max3_f32 v106, v71, v72, v106
    v_max3_f32 v106, v73, v74, v106
    v_max3_f32 v106, v75, v76, v106
    v_max3_f32 v106, v77, v78, v106
    v_max3_f32 v106, v79, v80, v106
    v_max3_f32 v106, v81, v82, v106
    v_max_f32 v106, v83, v106
    v_mov_b32 v3, v106
    s_nop 1
    v_permlane32_swap_b32 v106, v3
    v_max_f32 v106, v106, v3
    v_sub_f32 v12, 0xc2c00000, v106
    v_mov_b32 v13, v12
    v_mov_b32 v14, v12
    v_mov_b32 v15, v12
    v_mov_b32 v16, v12
    v_mov_b32 v17, v12
    v_mov_b32 v18, v12
    v_mov_b32 v19, v12
    v_mov_b32 v20, v12
    v_mov_b32 v21, v12
    v_mov_b32 v22, v12
    v_mov_b32 v23, v12
    v_mov_b32 v24, v12
    v_mov_b32 v25, v12
    v_mov_b32 v26, v12
    v_mov_b32 v27, v12
    s_nop 1
    v_mfma_f32_32x32x16_bf16 v[52:67], v[28:31], v[8:11], v[12:27]
    s_waitcnt lgkmcnt(0)
    s_nop 10
    s_setprio 1
    v_exp_f32 v52, v52
    v_exp_f32 v53, v53
    ds_read_b128 v[44:47], v102 offset:2112
    v_exp_f32 v54, v54
    v_exp_f32 v55, v55
    v_exp_f32 v56, v56
    v_exp_f32 v57, v57
    v_mfma_f32_32x32x16_bf16 v[68:83], v[32:35], v[8:11], v[12:27]
    ds_read_b128 v[28:31], v101 offset:4224
    s_add_u32 m0, s45, 24576
    s_add_u32 s48, s47, 24576
    buffer_load_dwordx4 v103, s[28:31], s48 offen sc1 lds
    v_exp_f32 v58, v58
    v_exp_f32 v59, v59
    v_exp_f32 v60, v60
    v_exp_f32 v61, v61
    v_exp_f32 v62, v62
    v_exp_f32 v63, v63
    v_smfmac_f32_32x32x32_bf16 v[84:99], v[36:39], v[52:59], v100
    s_waitcnt lgkmcnt(0)
    ds_read_b128 v[48:51], v102 offset:2656
    s_add_u32 m0, s45, 32768
    s_add_u32 s48, s47, 32768
    buffer_load_dwordx4 v103, s[28:31], s48 offen sc1 lds
    v_exp_f32 v64, v64
    v_exp_f32 v65, v65
    v_exp_f32 v66, v66
    v_exp_f32 v67, v67
    v_exp_f32 v68, v68
    v_exp_f32 v69, v69
    v_smfmac_f32_32x32x32_bf16 v[84:99], v[40:43], v[60:67], v100
    ds_read_b128 v[36:39], v102 offset:4224
    v_exp_f32 v70, v70
    v_exp_f32 v71, v71
    v_exp_f32 v72, v72
    v_exp_f32 v73, v73
    v_mfma_f32_32x32x16_bf16 v[52:67], v[28:31], v[8:11], v[12:27]
    ds_read_b128 v[32:35], v101 offset:6336
    s_add_u32 m0, s45, 40960
    s_add_u32 s48, s47, 40960
    buffer_load_dwordx4 v103, s[28:31], s48 offen sc1 lds
    v_exp_f32 v74, v74
    v_exp_f32 v75, v75
    v_exp_f32 v76, v76
    v_exp_f32 v77, v77
    v_exp_f32 v78, v78
    v_exp_f32 v79, v79
    v_smfmac_f32_32x32x32_bf16 v[84:99], v[44:47], v[68:75], v100
    s_waitcnt lgkmcnt(0)
    ds_read_b128 v[40:43], v102 offset:4768
    s_add_u32 m0, s45, 49152
    s_add_u32 s48, s47, 49152
    buffer_load_dwordx4 v103, s[28:31], s48 offen sc1 lds
    v_exp_f32 v80, v80
    v_exp_f32 v81, v81
    v_exp_f32 v82, v82
    v_exp_f32 v83, v83
    v_exp_f32 v52, v52
    v_exp_f32 v53, v53
    v_smfmac_f32_32x32x32_bf16 v[84:99], v[48:51], v[76:83], v100
    ds_read_b128 v[44:47], v102 offset:6336
    v_exp_f32 v54, v54
    v_exp_f32 v55, v55
    v_exp_f32 v56, v56
    v_exp_f32 v57, v57
    v_mfma_f32_32x32x16_bf16 v[68:83], v[32:35], v[8:11], v[12:27]
    ds_read_b128 v[28:31], v101 offset:8448
    s_add_u32 m0, s45, 57344
    s_add_u32 s48, s47, 57344
    buffer_load_dwordx4 v103, s[28:31], s48 offen sc1 lds
    v_exp_f32 v58, v58
    v_exp_f32 v59, v59
    v_exp_f32 v60, v60
    v_exp_f32 v61, v61
    v_exp_f32 v62, v62
    v_exp_f32 v63, v63
    v_smfmac_f32_32x32x32_bf16 v[84:99], v[36:39], v[52:59], v100
    s_waitcnt lgkmcnt(0)
    ds_read_b128 v[48:51], v102 offset:6880
    s_add_u32 m0, s45, 65536
    s_add_u32 s48, s47, 65536
    buffer_load_dwordx4 v103, s[28:31], s48 offen sc1 lds
    v_exp_f32 v64, v64
    v_exp_f32 v65, v65
    v_exp_f32 v66, v66
    v_exp_f32 v67, v67
    v_exp_f32 v68, v68
    v_exp_f32 v69, v69
    v_smfmac_f32_32x32x32_bf16 v[84:99], v[40:43], v[60:67], v100
    ds_read_b128 v[36:39], v102 offset:8448
    v_exp_f32 v70, v70
    v_exp_f32 v71, v71
    v_exp_f32 v72, v72
    v_exp_f32 v73, v73
    v_mfma_f32_32x32x16_bf16 v[52:67], v[28:31], v[8:11], v[12:27]
    ds_read_b128 v[32:35], v101 offset:10560
    s_add_u32 m0, s45, 73728
    s_add_u32 s48, s47, 73728
    buffer_load_dwordx4 v103, s[28:31], s48 offen sc1 lds
    v_exp_f32 v74, v74
    v_exp_f32 v75, v75
    v_exp_f32 v76, v76
    v_exp_f32 v77, v77
    v_exp_f32 v78, v78
    v_exp_f32 v79, v79
    v_smfmac_f32_32x32x32_bf16 v[84:99], v[44:47], v[68:75], v100
    s_waitcnt lgkmcnt(0)
    ds_read_b128 v[40:43], v102 offset:8992
    s_add_u32 m0, s45, 81920
    s_add_u32 s48, s47, 81920
    buffer_load_dwordx4 v103, s[28:31], s48 offen sc1 lds
    v_exp_f32 v80, v80
    v_exp_f32 v81, v81
    v_exp_f32 v82, v82
    v_exp_f32 v83, v83
    v_exp_f32 v52, v52
    v_exp_f32 v53, v53
    v_smfmac_f32_32x32x32_bf16 v[84:99], v[48:51], v[76:83], v100
    ds_read_b128 v[44:47], v102 offset:10560
    v_exp_f32 v54, v54
    v_exp_f32 v55, v55
    v_exp_f32 v56, v56
    v_exp_f32 v57, v57
    v_mfma_f32_32x32x16_bf16 v[68:83], v[32:35], v[8:11], v[12:27]
    ds_read_b128 v[28:31], v101 offset:12672
    s_add_u32 m0, s45, 90112
    s_add_u32 s48, s47, 90112
    buffer_load_dwordx4 v103, s[28:31], s48 offen sc1 lds
    v_exp_f32 v58, v58
    v_exp_f32 v59, v59
    v_exp_f32 v60, v60
    v_exp_f32 v61, v61
    v_exp_f32 v62, v62
    v_exp_f32 v63, v63
    v_smfmac_f32_32x32x32_bf16 v[84:99], v[36:39], v[52:59], v100
    s_waitcnt lgkmcnt(0)
    ds_read_b128 v[48:51], v102 offset:11104
    s_add_u32 m0, s45, 98304
    s_add_u32 s48, s47, 98304
    buffer_load_dwordx4 v103, s[28:31], s48 offen sc1 lds
    v_exp_f32 v64, v64
    v_exp_f32 v65, v65
    v_exp_f32 v66, v66
    v_exp_f32 v67, v67
    v_exp_f32 v68, v68
    v_exp_f32 v69, v69
    v_smfmac_f32_32x32x32_bf16 v[84:99], v[40:43], v[60:67], v100
    ds_read_b128 v[36:39], v102 offset:12672
    v_exp_f32 v70, v70
    v_exp_f32 v71, v71
    v_exp_f32 v72, v72
    v_exp_f32 v73, v73
    v_mfma_f32_32x32x16_bf16 v[52:67], v[28:31], v[8:11], v[12:27]
    ds_read_b128 v[32:35], v101 offset:14784
    s_add_u32 m0, s45, 106496
    s_add_u32 s48, s47, 106496
    buffer_load_dwordx4 v103, s[28:31], s48 offen sc1 lds
    v_exp_f32 v74, v74
    v_exp_f32 v75, v75
    v_exp_f32 v76, v76
    v_exp_f32 v77, v77
    v_exp_f32 v78, v78
    v_exp_f32 v79, v79
    v_smfmac_f32_32x32x32_bf16 v[84:99], v[44:47], v[68:75], v100
    s_waitcnt lgkmcnt(0)
    ds_read_b128 v[40:43], v102 offset:13216
    s_add_u32 m0, s45, 114688
    s_add_u32 s48, s47, 114688
    buffer_load_dwordx4 v103, s[28:31], s48 offen sc1 lds
    v_exp_f32 v80, v80
    v_exp_f32 v81, v81
    v_exp_f32 v82, v82
    v_exp_f32 v83, v83
    v_exp_f32 v52, v52
    v_exp_f32 v53, v53
    v_smfmac_f32_32x32x32_bf16 v[84:99], v[48:51], v[76:83], v100
    ds_read_b128 v[44:47], v102 offset:14784
    v_exp_f32 v54, v54
    v_exp_f32 v55, v55
    v_exp_f32 v56, v56
    v_exp_f32 v57, v57
    v_mfma_f32_32x32x16_bf16 v[68:83], v[32:35], v[8:11], v[12:27]
    ds_read_b128 v[28:31], v101 offset:16896
    s_add_u32 m0, s45, 122880
    s_add_u32 s48, s47, 122880
    buffer_load_dwordx4 v103, s[28:31], s48 offen sc1 lds
    v_exp_f32 v58, v58
    v_exp_f32 v59, v59
    v_exp_f32 v60, v60
    v_exp_f32 v61, v61
    v_exp_f32 v62, v62
    v_exp_f32 v63, v63
    v_smfmac_f32_32x32x32_bf16 v[84:99], v[36:39], v[52:59], v100
    s_waitcnt lgkmcnt(0)
    ds_read_b128 v[48:51], v102 offset:15328
    s_add_u32 m0, s45, 131072
    s_add_u32 s48, s47, s60
    buffer_load_dwordx4 v103, s[28:31], s48 offen sc1 lds
    v_exp_f32 v64, v64
    v_exp_f32 v65, v65
    v_exp_f32 v66, v66
    v_exp_f32 v67, v67
    v_exp_f32 v68, v68
    v_exp_f32 v69, v69
    v_smfmac_f32_32x32x32_bf16 v[84:99], v[40:43], v[60:67], v100
    ds_read_b128 v[36:39], v102 offset:16896
    v_exp_f32 v70, v70
    v_exp_f32 v71, v71
    v_exp_f32 v72, v72
    v_exp_f32 v73, v73
    v_mfma_f32_32x32x16_bf16 v[52:67], v[28:31], v[8:11], v[12:27]
    ds_read_b128 v[32:35], v101 offset:19008
    buffer_load_dwordx4 v[108:111], v103, s[28:31], s50 offen offset:0 sc1
    v_exp_f32 v74, v74
    v_exp_f32 v75, v75
    v_exp_f32 v76, v76
    v_exp_f32 v77, v77
    v_exp_f32 v78, v78
    v_exp_f32 v79, v79
    v_smfmac_f32_32x32x32_bf16 v[84:99], v[44:47], v[68:75], v100
    s_waitcnt lgkmcnt(0)
    ds_read_b128 v[40:43], v102 offset:17440
    buffer_load_dwordx4 v[112:115], v103, s[28:31], s50 offen offset:1024 sc1
    v_exp_f32 v80, v80
    v_exp_f32 v81, v81
    v_exp_f32 v82, v82
    v_exp_f32 v83, v83
    v_exp_f32 v52, v52
    v_exp_f32 v53, v53
    v_smfmac_f32_32x32x32_bf16 v[84:99], v[48:51], v[76:83], v100
    ds_read_b128 v[44:47], v102 offset:19008
    v_exp_f32 v54, v54
    v_exp_f32 v55, v55
    v_exp_f32 v56, v56
    v_exp_f32 v57, v57
    v_mfma_f32_32x32x16_bf16 v[68:83], v[32:35], v[8:11], v[12:27]
    ds_read_b128 v[28:31], v101 offset:21120
    buffer_load_dwordx4 v[116:119], v103, s[28:31], s50 offen offset:2048 sc1
    v_exp_f32 v58, v58
    v_exp_f32 v59, v59
    v_exp_f32 v60, v60
    v_exp_f32 v61, v61
    v_exp_f32 v62, v62
    v_exp_f32 v63, v63
    v_smfmac_f32_32x32x32_bf16 v[84:99], v[36:39], v[52:59], v100
    s_waitcnt lgkmcnt(0)
    ds_read_b128 v[48:51], v102 offset:19552
    buffer_load_dwordx4 v[120:123], v103, s[28:31], s50 offen offset:3072 sc1
    v_exp_f32 v64, v64
    v_exp_f32 v65, v65
    v_exp_f32 v66, v66
    v_exp_f32 v67, v67
    v_exp_f32 v68, v68
    v_exp_f32 v69, v69
    v_smfmac_f32_32x32x32_bf16 v[84:99], v[40:43], v[60:67], v100
    ds_read_b128 v[36:39], v102 offset:21120
    v_exp_f32 v70, v70
    v_exp_f32 v71, v71
    v_exp_f32 v72, v72
    v_exp_f32 v73, v73
    v_mfma_f32_32x32x16_bf16 v[52:67], v[28:31], v[8:11], v[12:27]
    ds_read_b128 v[32:35], v101 offset:23232
    s_add_u32 s50, s50, 4096
    buffer_load_dwordx4 v[124:127], v103, s[28:31], s50 offen offset:0 sc1
    v_exp_f32 v74, v74
    v_exp_f32 v75, v75
    v_exp_f32 v76, v76
    v_exp_f32 v77, v77
    v_exp_f32 v78, v78
    v_exp_f32 v79, v79
    v_smfmac_f32_32x32x32_bf16 v[84:99], v[44:47], v[68:75], v100
    s_waitcnt lgkmcnt(0)
    ds_read_b128 v[40:43], v102 offset:21664
    buffer_load_dwordx4 v[128:131], v103, s[28:31], s50 offen offset:1024 sc1
    v_exp_f32 v80, v80
    v_exp_f32 v81, v81
    v_exp_f32 v82, v82
    v_exp_f32 v83, v83
    s_waitcnt vmcnt(6)
    s_barrier
    v_exp_f32 v52, v52
    v_exp_f32 v53, v53
    v_smfmac_f32_32x32x32_bf16 v[84:99], v[48:51], v[76:83], v100
    ds_read_b128 v[44:47], v102 offset:23232
    v_exp_f32 v54, v54
    v_exp_f32 v55, v55
    v_exp_f32 v56, v56
    v_exp_f32 v57, v57
    v_mfma_f32_32x32x16_bf16 v[68:83], v[32:35], v[8:11], v[12:27]
    ds_read_b128 v[28:31], v101 offset:25344
    buffer_load_dwordx4 v[132:135], v103, s[28:31], s50 offen offset:2048 sc1
    v_exp_f32 v58, v58
    v_exp_f32 v59, v59
    v_exp_f32 v60, v60
    v_exp_f32 v61, v61
    v_exp_f32 v62, v62
    v_exp_f32 v63, v63
    v_smfmac_f32_32x32x32_bf16 v[84:99], v[36:39], v[52:59], v100
    s_waitcnt lgkmcnt(0)
    ds_read_b128 v[48:51], v102 offset:23776
    buffer_load_dwordx4 v[136:139], v103, s[28:31], s50 offen offset:3072 sc1
    v_exp_f32 v64, v64
    v_exp_f32 v65, v65
    v_exp_f32 v66, v66
    v_exp_f32 v67, v67
    v_exp_f32 v68, v68
    v_exp_f32 v69, v69
    v_smfmac_f32_32x32x32_bf16 v[84:99], v[40:43], v[60:67], v100
    ds_read_b128 v[36:39], v102 offset:25344
    v_exp_f32 v70, v70
    v_exp_f32 v71, v71
    v_exp_f32 v72, v72
    v_exp_f32 v73, v73
    v_mfma_f32_32x32x16_bf16 v[52:67], v[28:31], v[8:11], v[12:27]
    ds_read_b128 v[32:35], v101 offset:27456
    s_add_u32 s50, s50, 4096
    buffer_load_dwordx4 v[140:143], v103, s[28:31], s50 offen offset:0 sc1
    v_exp_f32 v74, v74
    v_exp_f32 v75, v75
    v_exp_f32 v76, v76
    v_exp_f32 v77, v77
    v_exp_f32 v78, v78
    v_exp_f32 v79, v79
    v_smfmac_f32_32x32x32_bf16 v[84:99], v[44:47], v[68:75], v100
    s_waitcnt lgkmcnt(0)
    ds_read_b128 v[40:43], v102 offset:25888
    buffer_load_dwordx4 v[144:147], v103, s[28:31], s50 offen offset:1024 sc1
    v_exp_f32 v80, v80
    v_exp_f32 v81, v81
    v_exp_f32 v82, v82
    v_exp_f32 v83, v83
    v_exp_f32 v52, v52
    v_exp_f32 v53, v53
    v_smfmac_f32_32x32x32_bf16 v[84:99], v[48:51], v[76:83], v100
    ds_read_b128 v[44:47], v102 offset:27456
    v_exp_f32 v54, v54
    v_exp_f32 v55, v55
    v_exp_f32 v56, v56
    v_exp_f32 v57, v57
    v_mfma_f32_32x32x16_bf16 v[68:83], v[32:35], v[8:11], v[12:27]
    ds_read_b128 v[28:31], v101 offset:29568
    buffer_load_dwordx4 v[148:151], v103, s[28:31], s50 offen offset:2048 sc1
    v_exp_f32 v58, v58
    v_exp_f32 v59, v59
    v_exp_f32 v60, v60
    v_exp_f32 v61, v61
    v_exp_f32 v62, v62
    v_exp_f32 v63, v63
    v_smfmac_f32_32x32x32_bf16 v[84:99], v[36:39], v[52:59], v100
    s_waitcnt lgkmcnt(0)
    ds_read_b128 v[48:51], v102 offset:28000
    buffer_load_dwordx4 v[152:155], v103, s[28:31], s50 offen offset:3072 sc1
    v_exp_f32 v64, v64
    v_exp_f32 v65, v65
    v_exp_f32 v66, v66
    v_exp_f32 v67, v67
    v_exp_f32 v68, v68
    v_exp_f32 v69, v69
    v_smfmac_f32_32x32x32_bf16 v[84:99], v[40:43], v[60:67], v100
    ds_read_b128 v[36:39], v102 offset:29568
    v_exp_f32 v70, v70
    v_exp_f32 v71, v71
    v_exp_f32 v72, v72
    v_exp_f32 v73, v73
    v_mfma_f32_32x32x16_bf16 v[52:67], v[28:31], v[8:11], v[12:27]
    ds_read_b128 v[32:35], v101 offset:31680
    s_add_u32 s50, s50, 4096
    buffer_load_dwordx4 v[156:159], v103, s[28:31], s50 offen offset:0 sc1
    v_exp_f32 v74, v74
    v_exp_f32 v75, v75
    v_exp_f32 v76, v76
    v_exp_f32 v77, v77
    v_exp_f32 v78, v78
    v_exp_f32 v79, v79
    v_smfmac_f32_32x32x32_bf16 v[84:99], v[44:47], v[68:75], v100
    s_waitcnt lgkmcnt(0)
    ds_read_b128 v[40:43], v102 offset:30112
    buffer_load_dwordx4 v[160:163], v103, s[28:31], s50 offen offset:1024 sc1
    v_exp_f32 v80, v80
    v_exp_f32 v81, v81
    v_exp_f32 v82, v82
    v_exp_f32 v83, v83
    v_exp_f32 v52, v52
    v_exp_f32 v53, v53
    v_smfmac_f32_32x32x32_bf16 v[84:99], v[48:51], v[76:83], v100
    ds_read_b128 v[44:47], v102 offset:31680
    v_exp_f32 v54, v54
    v_exp_f32 v55, v55
    v_exp_f32 v56, v56
    v_exp_f32 v57, v57
    v_mfma_f32_32x32x16_bf16 v[68:83], v[32:35], v[8:11], v[12:27]
    ds_read_b128 v[28:31], v101 offset:33792
    buffer_load_dwordx4 v[164:167], v103, s[28:31], s50 offen offset:2048 sc1
    v_exp_f32 v58, v58
    v_exp_f32 v59, v59
    v_exp_f32 v60, v60
    v_exp_f32 v61, v61
    v_exp_f32 v62, v62
    v_exp_f32 v63, v63
    v_smfmac_f32_32x32x32_bf16 v[84:99], v[36:39], v[52:59], v100
    s_waitcnt lgkmcnt(0)
    ds_read_b128 v[48:51], v102 offset:32224
    buffer_load_dwordx4 v[168:171], v103, s[28:31], s50 offen offset:3072 sc1
    v_exp_f32 v64, v64
    v_exp_f32 v65, v65
    v_exp_f32 v66, v66
    v_exp_f32 v67, v67
    v_exp_f32 v68, v68
    v_exp_f32 v69, v69
    v_smfmac_f32_32x32x32_bf16 v[84:99], v[40:43], v[60:67], v100
    ds_read_b128 v[36:39], v102 offset:33792
    v_exp_f32 v70, v70
    v_exp_f32 v71, v71
    v_exp_f32 v72, v72
    v_exp_f32 v73, v73
    v_mfma_f32_32x32x16_bf16 v[52:67], v[28:31], v[8:11], v[12:27]
    ds_read_b128 v[32:35], v101 offset:35904
    s_add_u32 s50, s50, 4096
    buffer_load_dwordx4 v[172:175], v103, s[28:31], s50 offen offset:0 sc1
    v_exp_f32 v74, v74
    v_exp_f32 v75, v75
    v_exp_f32 v76, v76
    v_exp_f32 v77, v77
    v_exp_f32 v78, v78
    v_exp_f32 v79, v79
    v_smfmac_f32_32x32x32_bf16 v[84:99], v[44:47], v[68:75], v100
    s_waitcnt lgkmcnt(0)
    ds_read_b128 v[40:43], v102 offset:34336
    buffer_load_dwordx4 v[176:179], v103, s[28:31], s50 offen offset:1024 sc1
    v_exp_f32 v80, v80
    v_exp_f32 v81, v81
    v_exp_f32 v82, v82
    v_exp_f32 v83, v83
    v_exp_f32 v52, v52
    v_exp_f32 v53, v53
    v_smfmac_f32_32x32x32_bf16 v[84:99], v[48:51], v[76:83], v100
    ds_read_b128 v[44:47], v102 offset:35904
    v_exp_f32 v54, v54
    v_exp_f32 v55, v55
    v_exp_f32 v56, v56
    v_exp_f32 v57, v57
    v_mfma_f32_32x32x16_bf16 v[68:83], v[32:35], v[8:11], v[12:27]
    ds_read_b128 v[28:31], v101 offset:38016
    buffer_load_dwordx4 v[180:183], v103, s[28:31], s50 offen offset:2048 sc1
    v_exp_f32 v58, v58
    v_exp_f32 v59, v59
    v_exp_f32 v60, v60
    v_exp_f32 v61, v61
    v_exp_f32 v62, v62
    v_exp_f32 v63, v63
    v_smfmac_f32_32x32x32_bf16 v[84:99], v[36:39], v[52:59], v100
    s_waitcnt lgkmcnt(0)
    ds_read_b128 v[48:51], v102 offset:36448
    buffer_load_dwordx4 v[184:187], v103, s[28:31], s50 offen offset:3072 sc1
    v_exp_f32 v64, v64
    v_exp_f32 v65, v65
    v_exp_f32 v66, v66
    v_exp_f32 v67, v67
    v_exp_f32 v68, v68
    v_exp_f32 v69, v69
    v_smfmac_f32_32x32x32_bf16 v[84:99], v[40:43], v[60:67], v100
    ds_read_b128 v[36:39], v102 offset:38016
    v_exp_f32 v70, v70
    v_exp_f32 v71, v71
    v_exp_f32 v72, v72
    v_exp_f32 v73, v73
    v_mfma_f32_32x32x16_bf16 v[52:67], v[28:31], v[8:11], v[12:27]
    ds_read_b128 v[32:35], v101 offset:40128
    s_add_u32 s50, s50, 4096
    buffer_load_dwordx4 v[188:191], v103, s[28:31], s50 offen offset:0 sc1
    v_exp_f32 v74, v74
    v_exp_f32 v75, v75
    v_exp_f32 v76, v76
    v_exp_f32 v77, v77
    v_exp_f32 v78, v78
    v_exp_f32 v79, v79
    v_smfmac_f32_32x32x32_bf16 v[84:99], v[44:47], v[68:75], v100
    s_waitcnt lgkmcnt(0)
    ds_read_b128 v[40:43], v102 offset:38560
    buffer_load_dwordx4 v[192:195], v103, s[28:31], s50 offen offset:1024 sc1
    v_exp_f32 v80, v80
    v_exp_f32 v81, v81
    v_exp_f32 v82, v82
    v_exp_f32 v83, v83
    v_exp_f32 v52, v52
    v_exp_f32 v53, v53
    v_smfmac_f32_32x32x32_bf16 v[84:99], v[48:51], v[76:83], v100
    ds_read_b128 v[44:47], v102 offset:40128
    v_exp_f32 v54, v54
    v_exp_f32 v55, v55
    v_exp_f32 v56, v56
    v_exp_f32 v57, v57
    v_mfma_f32_32x32x16_bf16 v[68:83], v[32:35], v[8:11], v[12:27]
    ds_read_b128 v[28:31], v101 offset:42240
    buffer_load_dwordx4 v[196:199], v103, s[28:31], s50 offen offset:2048 sc1
    v_exp_f32 v58, v58
    v_exp_f32 v59, v59
    v_exp_f32 v60, v60
    v_exp_f32 v61, v61
    v_exp_f32 v62, v62
    v_exp_f32 v63, v63
    v_smfmac_f32_32x32x32_bf16 v[84:99], v[36:39], v[52:59], v100
    s_waitcnt lgkmcnt(0)
    ds_read_b128 v[48:51], v102 offset:40672
    buffer_load_dwordx4 v[200:203], v103, s[28:31], s50 offen offset:3072 sc1
    v_exp_f32 v64, v64
    v_exp_f32 v65, v65
    v_exp_f32 v66, v66
    v_exp_f32 v67, v67
    v_exp_f32 v68, v68
    v_exp_f32 v69, v69
    v_smfmac_f32_32x32x32_bf16 v[84:99], v[40:43], v[60:67], v100
    ds_read_b128 v[36:39], v102 offset:42240
    v_exp_f32 v70, v70
    v_exp_f32 v71, v71
    v_exp_f32 v72, v72
    v_exp_f32 v73, v73
    v_mfma_f32_32x32x16_bf16 v[52:67], v[28:31], v[8:11], v[12:27]
    ds_read_b128 v[32:35], v101 offset:44352
    s_add_u32 s50, s50, 4096
    buffer_load_dwordx4 v[204:207], v103, s[28:31], s50 offen offset:0 sc1
    v_exp_f32 v74, v74
    v_exp_f32 v75, v75
    v_exp_f32 v76, v76
    v_exp_f32 v77, v77
    v_exp_f32 v78, v78
    v_exp_f32 v79, v79
    v_smfmac_f32_32x32x32_bf16 v[84:99], v[44:47], v[68:75], v100
    s_waitcnt lgkmcnt(0)
    ds_read_b128 v[40:43], v102 offset:42784
    buffer_load_dwordx4 v[208:211], v103, s[28:31], s50 offen offset:1024 sc1
    v_exp_f32 v80, v80
    v_exp_f32 v81, v81
    v_exp_f32 v82, v82
    v_exp_f32 v83, v83
    v_exp_f32 v52, v52
    v_exp_f32 v53, v53
    v_smfmac_f32_32x32x32_bf16 v[84:99], v[48:51], v[76:83], v100
    ds_read_b128 v[44:47], v102 offset:44352
    v_exp_f32 v54, v54
    v_exp_f32 v55, v55
    v_exp_f32 v56, v56
    v_exp_f32 v57, v57
    v_mfma_f32_32x32x16_bf16 v[68:83], v[32:35], v[8:11], v[12:27]
    ds_read_b128 v[28:31], v101 offset:46464
    buffer_load_dwordx4 v[212:215], v103, s[28:31], s50 offen offset:2048 sc1
    v_exp_f32 v58, v58
    v_exp_f32 v59, v59
    v_exp_f32 v60, v60
    v_exp_f32 v61, v61
    v_exp_f32 v62, v62
    v_exp_f32 v63, v63
    v_smfmac_f32_32x32x32_bf16 v[84:99], v[36:39], v[52:59], v100
    s_waitcnt lgkmcnt(0)
    ds_read_b128 v[48:51], v102 offset:44896
    buffer_load_dwordx4 v[216:219], v103, s[28:31], s50 offen offset:3072 sc1
    v_exp_f32 v64, v64
    v_exp_f32 v65, v65
    v_exp_f32 v66, v66
    v_exp_f32 v67, v67
    v_exp_f32 v68, v68
    v_exp_f32 v69, v69
    v_smfmac_f32_32x32x32_bf16 v[84:99], v[40:43], v[60:67], v100
    ds_read_b128 v[36:39], v102 offset:46464
    v_exp_f32 v70, v70
    v_exp_f32 v71, v71
    v_exp_f32 v72, v72
    v_exp_f32 v73, v73
    v_mfma_f32_32x32x16_bf16 v[52:67], v[28:31], v[8:11], v[12:27]
    ds_read_b128 v[32:35], v101 offset:48576
    s_add_u32 s50, s50, 4096
    buffer_load_dwordx4 v[220:223], v103, s[28:31], s50 offen offset:0 sc1
    v_exp_f32 v74, v74
    v_exp_f32 v75, v75
    v_exp_f32 v76, v76
    v_exp_f32 v77, v77
    v_exp_f32 v78, v78
    v_exp_f32 v79, v79
    v_smfmac_f32_32x32x32_bf16 v[84:99], v[44:47], v[68:75], v100
    s_waitcnt lgkmcnt(0)
    ds_read_b128 v[40:43], v102 offset:47008
    buffer_load_dwordx4 v[224:227], v103, s[28:31], s50 offen offset:1024 sc1
    v_exp_f32 v80, v80
    v_exp_f32 v81, v81
    v_exp_f32 v82, v82
    v_exp_f32 v83, v83
    v_exp_f32 v52, v52
    v_exp_f32 v53, v53
    v_smfmac_f32_32x32x32_bf16 v[84:99], v[48:51], v[76:83], v100
    ds_read_b128 v[44:47], v102 offset:48576
    v_exp_f32 v54, v54
    v_exp_f32 v55, v55
    v_exp_f32 v56, v56
    v_exp_f32 v57, v57
    v_mfma_f32_32x32x16_bf16 v[68:83], v[32:35], v[8:11], v[12:27]
    ds_read_b128 v[28:31], v101 offset:50688
    buffer_load_dwordx4 v[228:231], v103, s[28:31], s50 offen offset:2048 sc1
    v_exp_f32 v58, v58
    v_exp_f32 v59, v59
    v_exp_f32 v60, v60
    v_exp_f32 v61, v61
    v_exp_f32 v62, v62
    v_exp_f32 v63, v63
    v_smfmac_f32_32x32x32_bf16 v[84:99], v[36:39], v[52:59], v100
    s_waitcnt lgkmcnt(0)
    ds_read_b128 v[48:51], v102 offset:49120
    buffer_load_dwordx4 v[232:235], v103, s[28:31], s50 offen offset:3072 sc1
    v_exp_f32 v64, v64
    v_exp_f32 v65, v65
    v_exp_f32 v66, v66
    v_exp_f32 v67, v67
    v_exp_f32 v68, v68
    v_exp_f32 v69, v69
    v_smfmac_f32_32x32x32_bf16 v[84:99], v[40:43], v[60:67], v100
    ds_read_b128 v[36:39], v102 offset:50688
    v_exp_f32 v70, v70
    v_exp_f32 v71, v71
    v_exp_f32 v72, v72
    v_exp_f32 v73, v73
    v_mfma_f32_32x32x16_bf16 v[52:67], v[28:31], v[8:11], v[12:27]
    ds_read_b128 v[32:35], v101 offset:52800
    buffer_load_dword v236, v0, s[16:19], s44 offen offset:0
    v_exp_f32 v74, v74
    v_exp_f32 v75, v75
    v_exp_f32 v76, v76
    v_exp_f32 v77, v77
    v_exp_f32 v78, v78
    v_exp_f32 v79, v79
    v_smfmac_f32_32x32x32_bf16 v[84:99], v[44:47], v[68:75], v100
    s_waitcnt lgkmcnt(0)
    ds_read_b128 v[40:43], v102 offset:51232
    buffer_load_dword v237, v0, s[16:19], s44 offen offset:1024
    v_exp_f32 v80, v80
    v_exp_f32 v81, v81
    v_exp_f32 v82, v82
    v_exp_f32 v83, v83
    v_exp_f32 v52, v52
    v_exp_f32 v53, v53
    v_smfmac_f32_32x32x32_bf16 v[84:99], v[48:51], v[76:83], v100
    ds_read_b128 v[44:47], v102 offset:52800
    v_exp_f32 v54, v54
    v_exp_f32 v55, v55
    v_exp_f32 v56, v56
    v_exp_f32 v57, v57
    v_mfma_f32_32x32x16_bf16 v[68:83], v[32:35], v[8:11], v[12:27]
    ds_read_b128 v[28:31], v101 offset:54912
    buffer_load_dword v238, v0, s[16:19], s44 offen offset:2048
    v_exp_f32 v58, v58
    v_exp_f32 v59, v59
    v_exp_f32 v60, v60
    v_exp_f32 v61, v61
    v_exp_f32 v62, v62
    v_exp_f32 v63, v63
    v_smfmac_f32_32x32x32_bf16 v[84:99], v[36:39], v[52:59], v100
    s_waitcnt lgkmcnt(0)
    ds_read_b128 v[48:51], v102 offset:53344
    buffer_load_dword v239, v0, s[16:19], s44 offen offset:3072
    v_exp_f32 v64, v64
    v_exp_f32 v65, v65
    v_exp_f32 v66, v66
    v_exp_f32 v67, v67
    v_exp_f32 v68, v68
    v_exp_f32 v69, v69
    v_smfmac_f32_32x32x32_bf16 v[84:99], v[40:43], v[60:67], v100
    ds_read_b128 v[36:39], v102 offset:54912
    v_exp_f32 v70, v70
    v_exp_f32 v71, v71
    v_exp_f32 v72, v72
    v_exp_f32 v73, v73
    v_mfma_f32_32x32x16_bf16 v[52:67], v[28:31], v[8:11], v[12:27]
    ds_read_b128 v[32:35], v101 offset:57024
    buffer_load_dwordx4 v[240:243], v105, s[20:23], 0 offen
    v_exp_f32 v74, v74
    v_exp_f32 v75, v75
    v_exp_f32 v76, v76
    v_exp_f32 v77, v77
    v_exp_f32 v78, v78
    v_exp_f32 v79, v79
    v_smfmac_f32_32x32x32_bf16 v[84:99], v[44:47], v[68:75], v100
    s_waitcnt lgkmcnt(0)
    ds_read_b128 v[40:43], v102 offset:55456
    buffer_load_dwordx4 v[252:255], v244, s[4:7], s11 offen
    v_exp_f32 v80, v80
    v_exp_f32 v81, v81
    v_exp_f32 v82, v82
    v_exp_f32 v83, v83
    v_exp_f32 v52, v52
    v_exp_f32 v53, v53
    v_smfmac_f32_32x32x32_bf16 v[84:99], v[48:51], v[76:83], v100
    ds_read_b128 v[44:47], v102 offset:57024
    v_exp_f32 v54, v54
    v_exp_f32 v55, v55
    v_exp_f32 v56, v56
    v_exp_f32 v57, v57
    v_mfma_f32_32x32x16_bf16 v[68:83], v[32:35], v[8:11], v[12:27]
    ds_read_b128 v[28:31], v101 offset:59136
    v_exp_f32 v58, v58
    v_exp_f32 v59, v59
    v_exp_f32 v60, v60
    v_exp_f32 v61, v61
    v_exp_f32 v62, v62
    v_exp_f32 v63, v63
    v_smfmac_f32_32x32x32_bf16 v[84:99], v[36:39], v[52:59], v100
    s_waitcnt lgkmcnt(0)
    ds_read_b128 v[48:51], v102 offset:57568
    v_exp_f32 v64, v64
    v_exp_f32 v65, v65
    v_exp_f32 v66, v66
    v_exp_f32 v67, v67
    v_exp_f32 v68, v68
    v_exp_f32 v69, v69
    v_smfmac_f32_32x32x32_bf16 v[84:99], v[40:43], v[60:67], v100
    ds_read_b128 v[36:39], v102 offset:59136
    v_exp_f32 v70, v70
    v_exp_f32 v71, v71
    v_exp_f32 v72, v72
    v_exp_f32 v73, v73
    v_mfma_f32_32x32x16_bf16 v[52:67], v[28:31], v[8:11], v[12:27]
    ds_read_b128 v[32:35], v101 offset:61248
    v_exp_f32 v74, v74
    v_exp_f32 v75, v75
    v_exp_f32 v76, v76
    v_exp_f32 v77, v77
    v_exp_f32 v78, v78
    v_exp_f32 v79, v79
    v_smfmac_f32_32x32x32_bf16 v[84:99], v[44:47], v[68:75], v100
    s_waitcnt lgkmcnt(0)
    ds_read_b128 v[40:43], v102 offset:59680
    v_exp_f32 v80, v80
    v_exp_f32 v81, v81
    v_exp_f32 v82, v82
    v_exp_f32 v83, v83
    v_exp_f32 v52, v52
    v_exp_f32 v53, v53
    v_smfmac_f32_32x32x32_bf16 v[84:99], v[48:51], v[76:83], v100
    ds_read_b128 v[44:47], v102 offset:61248
    v_exp_f32 v54, v54
    v_exp_f32 v55, v55
    v_exp_f32 v56, v56
    v_exp_f32 v57, v57
    v_mfma_f32_32x32x16_bf16 v[68:83], v[32:35], v[8:11], v[12:27]
    ds_read_b128 v[28:31], v101 offset:63360
    v_exp_f32 v58, v58
    v_exp_f32 v59, v59
    v_exp_f32 v60, v60
    v_exp_f32 v61, v61
    v_exp_f32 v62, v62
    v_exp_f32 v63, v63
    v_smfmac_f32_32x32x32_bf16 v[84:99], v[36:39], v[52:59], v100
    s_waitcnt lgkmcnt(0)
    ds_read_b128 v[48:51], v102 offset:61792
    v_exp_f32 v64, v64
    v_exp_f32 v65, v65
    v_exp_f32 v66, v66
    v_exp_f32 v67, v67
    v_add_u32 v101, 61248, v101
    v_add_u32 v102, 61248, v102
    v_exp_f32 v68, v68
    v_exp_f32 v69, v69
    v_smfmac_f32_32x32x32_bf16 v[84:99], v[40:43], v[60:67], v100
    ds_read_b128 v[36:39], v102 offset:2112
    v_exp_f32 v70, v70
    v_exp_f32 v71, v71
    v_exp_f32 v72, v72
    v_exp_f32 v73, v73
    v_mfma_f32_32x32x16_bf16 v[52:67], v[28:31], v[8:11], v[12:27]
    ds_read_b128 v[32:35], v101 offset:4224
    v_exp_f32 v74, v74
    v_exp_f32 v75, v75
    v_exp_f32 v76, v76
    v_exp_f32 v77, v77
    v_exp_f32 v78, v78
    v_exp_f32 v79, v79
    v_smfmac_f32_32x32x32_bf16 v[84:99], v[44:47], v[68:75], v100
    s_waitcnt lgkmcnt(0)
    ds_read_b128 v[40:43], v102 offset:2656
    v_exp_f32 v80, v80
    v_exp_f32 v81, v81
    v_exp_f32 v82, v82
    v_exp_f32 v83, v83
    v_exp_f32 v52, v52
    v_exp_f32 v53, v53
    v_smfmac_f32_32x32x32_bf16 v[84:99], v[48:51], v[76:83], v100
    ds_read_b128 v[44:47], v102 offset:4224
    v_exp_f32 v54, v54
    v_exp_f32 v55, v55
    v_exp_f32 v56, v56
    v_exp_f32 v57, v57
    v_mfma_f32_32x32x16_bf16 v[68:83], v[32:35], v[8:11], v[12:27]
    ds_read_b128 v[28:31], v101 offset:6336
    v_exp_f32 v58, v58
    v_exp_f32 v59, v59
    v_exp_f32 v60, v60
    v_exp_f32 v61, v61
    v_exp_f32 v62, v62
    v_exp_f32 v63, v63
    v_smfmac_f32_32x32x32_bf16 v[84:99], v[36:39], v[52:59], v100
    s_waitcnt lgkmcnt(0)
    ds_read_b128 v[48:51], v102 offset:4768
    v_exp_f32 v64, v64
    v_exp_f32 v65, v65
    v_exp_f32 v66, v66
    v_exp_f32 v67, v67
    v_exp_f32 v68, v68
    v_exp_f32 v69, v69
    v_smfmac_f32_32x32x32_bf16 v[84:99], v[40:43], v[60:67], v100
    ds_read_b128 v[36:39], v102 offset:6336
    v_exp_f32 v70, v70
    v_exp_f32 v71, v71
    v_exp_f32 v72, v72
    v_exp_f32 v73, v73
    v_mfma_f32_32x32x16_bf16 v[52:67], v[28:31], v[8:11], v[12:27]
    ds_read_b128 v[32:35], v101 offset:8448
    v_exp_f32 v74, v74
    v_exp_f32 v75, v75
    v_exp_f32 v76, v76
    v_exp_f32 v77, v77
    v_exp_f32 v78, v78
    v_exp_f32 v79, v79
    v_smfmac_f32_32x32x32_bf16 v[84:99], v[44:47], v[68:75], v100
    s_waitcnt lgkmcnt(0)
    ds_read_b128 v[40:43], v102 offset:6880
    v_exp_f32 v80, v80
    v_exp_f32 v81, v81
    v_exp_f32 v82, v82
    v_exp_f32 v83, v83
    v_exp_f32 v52, v52
    v_exp_f32 v53, v53
    v_smfmac_f32_32x32x32_bf16 v[84:99], v[48:51], v[76:83], v100
    ds_read_b128 v[44:47], v102 offset:8448
    v_exp_f32 v54, v54
    v_exp_f32 v55, v55
    v_exp_f32 v56, v56
    v_exp_f32 v57, v57
    v_mfma_f32_32x32x16_bf16 v[68:83], v[32:35], v[8:11], v[12:27]
    ds_read_b128 v[28:31], v101 offset:10560
    v_exp_f32 v58, v58
    v_exp_f32 v59, v59
    v_exp_f32 v60, v60
    v_exp_f32 v61, v61
    v_exp_f32 v62, v62
    v_exp_f32 v63, v63
    v_smfmac_f32_32x32x32_bf16 v[84:99], v[36:39], v[52:59], v100
    s_waitcnt lgkmcnt(0)
    ds_read_b128 v[48:51], v102 offset:8992
    v_exp_f32 v64, v64
    v_exp_f32 v65, v65
    v_exp_f32 v66, v66
    v_exp_f32 v67, v67
    v_exp_f32 v68, v68
    v_exp_f32 v69, v69
    v_smfmac_f32_32x32x32_bf16 v[84:99], v[40:43], v[60:67], v100
    ds_read_b128 v[36:39], v102 offset:10560
    v_exp_f32 v70, v70
    v_exp_f32 v71, v71
    v_exp_f32 v72, v72
    v_exp_f32 v73, v73
    v_mfma_f32_32x32x16_bf16 v[52:67], v[28:31], v[8:11], v[12:27]
    ds_read_b128 v[32:35], v101 offset:12672
    v_exp_f32 v74, v74
    v_exp_f32 v75, v75
    v_exp_f32 v76, v76
    v_exp_f32 v77, v77
    v_exp_f32 v78, v78
    v_exp_f32 v79, v79
    v_smfmac_f32_32x32x32_bf16 v[84:99], v[44:47], v[68:75], v100
    s_waitcnt lgkmcnt(0)
    ds_read_b128 v[40:43], v102 offset:11104
    v_exp_f32 v80, v80
    v_exp_f32 v81, v81
    v_exp_f32 v82, v82
    v_exp_f32 v83, v83
    v_exp_f32 v52, v52
    v_exp_f32 v53, v53
    v_smfmac_f32_32x32x32_bf16 v[84:99], v[48:51], v[76:83], v100
    ds_read_b128 v[44:47], v102 offset:12672
    v_exp_f32 v54, v54
    v_exp_f32 v55, v55
    v_exp_f32 v56, v56
    v_exp_f32 v57, v57
    v_mfma_f32_32x32x16_bf16 v[68:83], v[32:35], v[8:11], v[12:27]
    ds_read_b128 v[28:31], v101 offset:14784
    v_exp_f32 v58, v58
    v_exp_f32 v59, v59
    v_exp_f32 v60, v60
    v_exp_f32 v61, v61
    v_exp_f32 v62, v62
    v_exp_f32 v63, v63
    v_smfmac_f32_32x32x32_bf16 v[84:99], v[36:39], v[52:59], v100
    s_waitcnt lgkmcnt(0)
    ds_read_b128 v[48:51], v102 offset:13216
    v_exp_f32 v64, v64
    v_exp_f32 v65, v65
    v_exp_f32 v66, v66
    v_exp_f32 v67, v67
    v_exp_f32 v68, v68
    v_exp_f32 v69, v69
    v_smfmac_f32_32x32x32_bf16 v[84:99], v[40:43], v[60:67], v100
    ds_read_b128 v[36:39], v102 offset:14784
    v_exp_f32 v70, v70
    v_exp_f32 v71, v71
    v_exp_f32 v72, v72
    v_exp_f32 v73, v73
    v_mfma_f32_32x32x16_bf16 v[52:67], v[28:31], v[8:11], v[12:27]
    ds_read_b128 v[32:35], v101 offset:16896
    v_exp_f32 v74, v74
    v_exp_f32 v75, v75
    v_exp_f32 v76, v76
    v_exp_f32 v77, v77
    v_exp_f32 v78, v78
    v_exp_f32 v79, v79
    v_smfmac_f32_32x32x32_bf16 v[84:99], v[44:47], v[68:75], v100
    s_waitcnt lgkmcnt(0)
    ds_read_b128 v[40:43], v102 offset:15328
    v_exp_f32 v80, v80
    v_exp_f32 v81, v81
    v_exp_f32 v82, v82
    v_exp_f32 v83, v83
    v_exp_f32 v52, v52
    v_exp_f32 v53, v53
    v_smfmac_f32_32x32x32_bf16 v[84:99], v[48:51], v[76:83], v100
    ds_read_b128 v[44:47], v102 offset:16896
    v_exp_f32 v54, v54
    v_exp_f32 v55, v55
    v_exp_f32 v56, v56
    v_exp_f32 v57, v57
    v_mfma_f32_32x32x16_bf16 v[68:83], v[32:35], v[8:11], v[12:27]
    ds_read_b128 v[28:31], v101 offset:19008
    v_exp_f32 v58, v58
    v_exp_f32 v59, v59
    v_exp_f32 v60, v60
    v_exp_f32 v61, v61
    v_exp_f32 v62, v62
    v_exp_f32 v63, v63
    v_smfmac_f32_32x32x32_bf16 v[84:99], v[36:39], v[52:59], v100
    s_waitcnt lgkmcnt(0)
    ds_read_b128 v[48:51], v102 offset:17440
    v_exp_f32 v64, v64
    v_exp_f32 v65, v65
    v_exp_f32 v66, v66
    v_exp_f32 v67, v67
    v_exp_f32 v68, v68
    v_exp_f32 v69, v69
    v_smfmac_f32_32x32x32_bf16 v[84:99], v[40:43], v[60:67], v100
    ds_read_b128 v[36:39], v102 offset:19008
    v_exp_f32 v70, v70
    v_exp_f32 v71, v71
    v_exp_f32 v72, v72
    v_exp_f32 v73, v73
    v_mfma_f32_32x32x16_bf16 v[52:67], v[28:31], v[8:11], v[12:27]
    ds_read_b128 v[32:35], v101 offset:21120
    v_exp_f32 v74, v74
    v_exp_f32 v75, v75
    v_exp_f32 v76, v76
    v_exp_f32 v77, v77
    v_exp_f32 v78, v78
    v_exp_f32 v79, v79
    v_smfmac_f32_32x32x32_bf16 v[84:99], v[44:47], v[68:75], v100
    s_waitcnt lgkmcnt(0)
    ds_read_b128 v[40:43], v102 offset:19552
    v_exp_f32 v80, v80
    v_exp_f32 v81, v81
    v_exp_f32 v82, v82
    v_exp_f32 v83, v83
    v_exp_f32 v52, v52
    v_exp_f32 v53, v53
    v_smfmac_f32_32x32x32_bf16 v[84:99], v[48:51], v[76:83], v100
    ds_read_b128 v[44:47], v102 offset:21120
    v_exp_f32 v54, v54
    v_exp_f32 v55, v55
    v_exp_f32 v56, v56
    v_exp_f32 v57, v57
    v_mfma_f32_32x32x16_bf16 v[68:83], v[32:35], v[8:11], v[12:27]
    ds_read_b128 v[28:31], v101 offset:23232
    v_exp_f32 v58, v58
    v_exp_f32 v59, v59
    v_exp_f32 v60, v60
    v_exp_f32 v61, v61
    v_exp_f32 v62, v62
    v_exp_f32 v63, v63
    v_smfmac_f32_32x32x32_bf16 v[84:99], v[36:39], v[52:59], v100
    s_waitcnt lgkmcnt(0)
    ds_read_b128 v[48:51], v102 offset:21664
    v_exp_f32 v64, v64
    v_exp_f32 v65, v65
    v_exp_f32 v66, v66
    v_exp_f32 v67, v67
    v_exp_f32 v68, v68
    v_exp_f32 v69, v69
    v_smfmac_f32_32x32x32_bf16 v[84:99], v[40:43], v[60:67], v100
    ds_read_b128 v[36:39], v102 offset:23232
    v_exp_f32 v70, v70
    v_exp_f32 v71, v71
    v_exp_f32 v72, v72
    v_exp_f32 v73, v73
    v_mfma_f32_32x32x16_bf16 v[52:67], v[28:31], v[8:11], v[12:27]
    ds_read_b128 v[32:35], v101 offset:25344
    v_exp_f32 v74, v74
    v_exp_f32 v75, v75
    v_exp_f32 v76, v76
    v_exp_f32 v77, v77
    v_exp_f32 v78, v78
    v_exp_f32 v79, v79
    v_smfmac_f32_32x32x32_bf16 v[84:99], v[44:47], v[68:75], v100
    s_waitcnt lgkmcnt(0)
    ds_read_b128 v[40:43], v102 offset:23776
    v_exp_f32 v80, v80
    v_exp_f32 v81, v81
    v_exp_f32 v82, v82
    v_exp_f32 v83, v83
    v_exp_f32 v52, v52
    v_exp_f32 v53, v53
    v_smfmac_f32_32x32x32_bf16 v[84:99], v[48:51], v[76:83], v100
    ds_read_b128 v[44:47], v102 offset:25344
    v_exp_f32 v54, v54
    v_exp_f32 v55, v55
    v_exp_f32 v56, v56
    v_exp_f32 v57, v57
    v_mfma_f32_32x32x16_bf16 v[68:83], v[32:35], v[8:11], v[12:27]
    ds_read_b128 v[28:31], v101 offset:27456
    v_exp_f32 v58, v58
    v_exp_f32 v59, v59
    v_exp_f32 v60, v60
    v_exp_f32 v61, v61
    v_exp_f32 v62, v62
    v_exp_f32 v63, v63
    v_smfmac_f32_32x32x32_bf16 v[84:99], v[36:39], v[52:59], v100
    s_waitcnt lgkmcnt(0)
    ds_read_b128 v[48:51], v102 offset:25888
    v_exp_f32 v64, v64
    v_exp_f32 v65, v65
    v_exp_f32 v66, v66
    v_exp_f32 v67, v67
    v_exp_f32 v68, v68
    v_exp_f32 v69, v69
    v_smfmac_f32_32x32x32_bf16 v[84:99], v[40:43], v[60:67], v100
    ds_read_b128 v[36:39], v102 offset:27456
    v_exp_f32 v70, v70
    v_exp_f32 v71, v71
    v_exp_f32 v72, v72
    v_exp_f32 v73, v73
    v_mfma_f32_32x32x16_bf16 v[52:67], v[28:31], v[8:11], v[12:27]
    ds_read_b128 v[32:35], v101 offset:29568
    v_exp_f32 v74, v74
    v_exp_f32 v75, v75
    v_exp_f32 v76, v76
    v_exp_f32 v77, v77
    v_exp_f32 v78, v78
    v_exp_f32 v79, v79
    v_smfmac_f32_32x32x32_bf16 v[84:99], v[44:47], v[68:75], v100
    s_waitcnt lgkmcnt(0)
    ds_read_b128 v[40:43], v102 offset:28000
    v_exp_f32 v80, v80
    v_exp_f32 v81, v81
    v_exp_f32 v82, v82
    v_exp_f32 v83, v83
    v_exp_f32 v52, v52
    v_exp_f32 v53, v53
    v_smfmac_f32_32x32x32_bf16 v[84:99], v[48:51], v[76:83], v100
    ds_read_b128 v[44:47], v102 offset:29568
    v_exp_f32 v54, v54
    v_exp_f32 v55, v55
    v_exp_f32 v56, v56
    v_exp_f32 v57, v57
    v_mfma_f32_32x32x16_bf16 v[68:83], v[32:35], v[8:11], v[12:27]
    ds_read_b128 v[28:31], v101 offset:31680
    v_exp_f32 v58, v58
    v_exp_f32 v59, v59
    v_exp_f32 v60, v60
    v_exp_f32 v61, v61
    v_exp_f32 v62, v62
    v_exp_f32 v63, v63
    v_smfmac_f32_32x32x32_bf16 v[84:99], v[36:39], v[52:59], v100
    s_waitcnt lgkmcnt(0)
    ds_read_b128 v[48:51], v102 offset:30112
    v_exp_f32 v64, v64
    v_exp_f32 v65, v65
    v_exp_f32 v66, v66
    v_exp_f32 v67, v67
    v_exp_f32 v68, v68
    v_exp_f32 v69, v69
    v_smfmac_f32_32x32x32_bf16 v[84:99], v[40:43], v[60:67], v100
    ds_read_b128 v[36:39], v102 offset:31680
    v_exp_f32 v70, v70
    v_exp_f32 v71, v71
    v_exp_f32 v72, v72
    v_exp_f32 v73, v73
    v_mfma_f32_32x32x16_bf16 v[52:67], v[28:31], v[8:11], v[12:27]
    ds_read_b128 v[32:35], v101 offset:33792
    v_exp_f32 v74, v74
    v_exp_f32 v75, v75
    v_exp_f32 v76, v76
    v_exp_f32 v77, v77
    v_exp_f32 v78, v78
    v_exp_f32 v79, v79
    v_smfmac_f32_32x32x32_bf16 v[84:99], v[44:47], v[68:75], v100
    s_waitcnt lgkmcnt(0)
    ds_read_b128 v[40:43], v102 offset:32224
    v_exp_f32 v80, v80
    v_exp_f32 v81, v81
    v_exp_f32 v82, v82
    v_exp_f32 v83, v83
    v_exp_f32 v52, v52
    v_exp_f32 v53, v53
    v_smfmac_f32_32x32x32_bf16 v[84:99], v[48:51], v[76:83], v100
    ds_read_b128 v[44:47], v102 offset:33792
    v_exp_f32 v54, v54
    v_exp_f32 v55, v55
    v_exp_f32 v56, v56
    v_exp_f32 v57, v57
    v_mfma_f32_32x32x16_bf16 v[68:83], v[32:35], v[8:11], v[12:27]
    ds_read_b128 v[28:31], v101 offset:35904
    v_exp_f32 v58, v58
    v_exp_f32 v59, v59
    v_exp_f32 v60, v60
    v_exp_f32 v61, v61
    v_exp_f32 v62, v62
    v_exp_f32 v63, v63
    v_smfmac_f32_32x32x32_bf16 v[84:99], v[36:39], v[52:59], v100
    s_waitcnt lgkmcnt(0)
    ds_read_b128 v[48:51], v102 offset:34336
    v_exp_f32 v64, v64
    v_exp_f32 v65, v65
    v_exp_f32 v66, v66
    v_exp_f32 v67, v67
    v_exp_f32 v68, v68
    v_exp_f32 v69, v69
    v_smfmac_f32_32x32x32_bf16 v[84:99], v[40:43], v[60:67], v100
    ds_read_b128 v[36:39], v102 offset:35904
    v_exp_f32 v70, v70
    v_exp_f32 v71, v71
    v_exp_f32 v72, v72
    v_exp_f32 v73, v73
    v_mfma_f32_32x32x16_bf16 v[52:67], v[28:31], v[8:11], v[12:27]
    ds_read_b128 v[32:35], v101 offset:38016
    v_exp_f32 v74, v74
    v_exp_f32 v75, v75
    v_exp_f32 v76, v76
    v_exp_f32 v77, v77
    v_exp_f32 v78, v78
    v_exp_f32 v79, v79
    v_smfmac_f32_32x32x32_bf16 v[84:99], v[44:47], v[68:75], v100
    s_waitcnt lgkmcnt(0)
    ds_read_b128 v[40:43], v102 offset:36448
    v_exp_f32 v80, v80
    v_exp_f32 v81, v81
    v_exp_f32 v82, v82
    v_exp_f32 v83, v83
    v_exp_f32 v52, v52
    v_exp_f32 v53, v53
    v_smfmac_f32_32x32x32_bf16 v[84:99], v[48:51], v[76:83], v100
    ds_read_b128 v[44:47], v102 offset:38016
    v_exp_f32 v54, v54
    v_exp_f32 v55, v55
    v_exp_f32 v56, v56
    v_exp_f32 v57, v57
    v_mfma_f32_32x32x16_bf16 v[68:83], v[32:35], v[8:11], v[12:27]
    ds_read_b128 v[28:31], v101 offset:40128
    v_exp_f32 v58, v58
    v_exp_f32 v59, v59
    v_exp_f32 v60, v60
    v_exp_f32 v61, v61
    v_exp_f32 v62, v62
    v_exp_f32 v63, v63
    v_smfmac_f32_32x32x32_bf16 v[84:99], v[36:39], v[52:59], v100
    s_waitcnt lgkmcnt(0)
    ds_read_b128 v[48:51], v102 offset:38560
    v_exp_f32 v64, v64
    v_exp_f32 v65, v65
    v_exp_f32 v66, v66
    v_exp_f32 v67, v67
    v_exp_f32 v68, v68
    v_exp_f32 v69, v69
    v_smfmac_f32_32x32x32_bf16 v[84:99], v[40:43], v[60:67], v100
    ds_read_b128 v[36:39], v102 offset:40128
    v_exp_f32 v70, v70
    v_exp_f32 v71, v71
    v_exp_f32 v72, v72
    v_exp_f32 v73, v73
    v_mfma_f32_32x32x16_bf16 v[52:67], v[28:31], v[8:11], v[12:27]
    ds_read_b128 v[32:35], v101 offset:42240
    v_exp_f32 v74, v74
    v_exp_f32 v75, v75
    v_exp_f32 v76, v76
    v_exp_f32 v77, v77
    v_exp_f32 v78, v78
    v_exp_f32 v79, v79
    v_smfmac_f32_32x32x32_bf16 v[84:99], v[44:47], v[68:75], v100
    s_waitcnt lgkmcnt(0)
    ds_read_b128 v[40:43], v102 offset:40672
    v_exp_f32 v80, v80
    v_exp_f32 v81, v81
    v_exp_f32 v82, v82
    v_exp_f32 v83, v83
    v_exp_f32 v52, v52
    v_exp_f32 v53, v53
    v_smfmac_f32_32x32x32_bf16 v[84:99], v[48:51], v[76:83], v100
    ds_read_b128 v[44:47], v102 offset:42240
    v_exp_f32 v54, v54
    v_exp_f32 v55, v55
    v_exp_f32 v56, v56
    v_exp_f32 v57, v57
    v_mfma_f32_32x32x16_bf16 v[68:83], v[32:35], v[8:11], v[12:27]
    ds_read_b128 v[28:31], v101 offset:44352
    v_exp_f32 v58, v58
    v_exp_f32 v59, v59
    v_exp_f32 v60, v60
    v_exp_f32 v61, v61
    v_exp_f32 v62, v62
    v_exp_f32 v63, v63
    v_smfmac_f32_32x32x32_bf16 v[84:99], v[36:39], v[52:59], v100
    s_waitcnt lgkmcnt(0)
    ds_read_b128 v[48:51], v102 offset:42784
    v_exp_f32 v64, v64
    v_exp_f32 v65, v65
    v_exp_f32 v66, v66
    v_exp_f32 v67, v67
    v_exp_f32 v68, v68
    v_exp_f32 v69, v69
    v_smfmac_f32_32x32x32_bf16 v[84:99], v[40:43], v[60:67], v100
    ds_read_b128 v[36:39], v102 offset:44352
    v_exp_f32 v70, v70
    v_exp_f32 v71, v71
    v_exp_f32 v72, v72
    v_exp_f32 v73, v73
    v_mfma_f32_32x32x16_bf16 v[52:67], v[28:31], v[8:11], v[12:27]
    ds_read_b128 v[32:35], v101 offset:46464
    v_exp_f32 v74, v74
    v_exp_f32 v75, v75
    v_exp_f32 v76, v76
    v_exp_f32 v77, v77
    v_exp_f32 v78, v78
    v_exp_f32 v79, v79
    v_smfmac_f32_32x32x32_bf16 v[84:99], v[44:47], v[68:75], v100
    s_waitcnt lgkmcnt(0)
    ds_read_b128 v[40:43], v102 offset:44896
    v_exp_f32 v80, v80
    v_exp_f32 v81, v81
    v_exp_f32 v82, v82
    v_exp_f32 v83, v83
    v_exp_f32 v52, v52
    v_exp_f32 v53, v53
    v_smfmac_f32_32x32x32_bf16 v[84:99], v[48:51], v[76:83], v100
    ds_read_b128 v[44:47], v102 offset:46464
    v_exp_f32 v54, v54
    v_exp_f32 v55, v55
    v_exp_f32 v56, v56
    v_exp_f32 v57, v57
    v_mfma_f32_32x32x16_bf16 v[68:83], v[32:35], v[8:11], v[12:27]
    ds_read_b128 v[28:31], v101 offset:48576
    v_exp_f32 v58, v58
    v_exp_f32 v59, v59
    v_exp_f32 v60, v60
    v_exp_f32 v61, v61
    v_exp_f32 v62, v62
    v_exp_f32 v63, v63
    v_smfmac_f32_32x32x32_bf16 v[84:99], v[36:39], v[52:59], v100
    s_waitcnt lgkmcnt(0)
    ds_read_b128 v[48:51], v102 offset:47008
    v_exp_f32 v64, v64
    v_exp_f32 v65, v65
    v_exp_f32 v66, v66
    v_exp_f32 v67, v67
    v_exp_f32 v68, v68
    v_exp_f32 v69, v69
    v_smfmac_f32_32x32x32_bf16 v[84:99], v[40:43], v[60:67], v100
    ds_read_b128 v[36:39], v102 offset:48576
    v_exp_f32 v70, v70
    v_exp_f32 v71, v71
    v_exp_f32 v72, v72
    v_exp_f32 v73, v73
    v_mfma_f32_32x32x16_bf16 v[52:67], v[28:31], v[8:11], v[12:27]
    ds_read_b128 v[32:35], v101 offset:50688
    v_exp_f32 v74, v74
    v_exp_f32 v75, v75
    v_exp_f32 v76, v76
    v_exp_f32 v77, v77
    v_exp_f32 v78, v78
    v_exp_f32 v79, v79
    v_smfmac_f32_32x32x32_bf16 v[84:99], v[44:47], v[68:75], v100
    s_waitcnt lgkmcnt(0)
    ds_read_b128 v[40:43], v102 offset:49120
    v_exp_f32 v80, v80
    v_exp_f32 v81, v81
    v_exp_f32 v82, v82
    v_exp_f32 v83, v83
    v_exp_f32 v52, v52
    v_exp_f32 v53, v53
    v_smfmac_f32_32x32x32_bf16 v[84:99], v[48:51], v[76:83], v100
    ds_read_b128 v[44:47], v102 offset:50688
    v_exp_f32 v54, v54
    v_exp_f32 v55, v55
    v_exp_f32 v56, v56
    v_exp_f32 v57, v57
    v_mfma_f32_32x32x16_bf16 v[68:83], v[32:35], v[8:11], v[12:27]
    ds_read_b128 v[28:31], v101 offset:52800
    buffer_load_dwordx4 v[244:247], v1, s[32:35], s65 offen
    v_exp_f32 v58, v58
    v_exp_f32 v59, v59
    v_exp_f32 v60, v60
    v_exp_f32 v61, v61
    v_exp_f32 v62, v62
    v_exp_f32 v63, v63
    v_smfmac_f32_32x32x32_bf16 v[84:99], v[36:39], v[52:59], v100
    s_waitcnt lgkmcnt(0)
    ds_read_b128 v[48:51], v102 offset:51232
    v_exp_f32 v64, v64
    v_exp_f32 v65, v65
    v_exp_f32 v66, v66
    v_exp_f32 v67, v67
    v_exp_f32 v68, v68
    v_exp_f32 v69, v69
    v_smfmac_f32_32x32x32_bf16 v[84:99], v[40:43], v[60:67], v100
    ds_read_b128 v[36:39], v102 offset:52800
    v_exp_f32 v70, v70
    v_exp_f32 v71, v71
    v_exp_f32 v72, v72
    v_exp_f32 v73, v73
    v_mfma_f32_32x32x16_bf16 v[52:67], v[28:31], v[8:11], v[12:27]
    ds_read_b128 v[32:35], v101 offset:54912
    v_exp_f32 v74, v74
    v_exp_f32 v75, v75
    v_exp_f32 v76, v76
    v_exp_f32 v77, v77
    v_exp_f32 v78, v78
    v_exp_f32 v79, v79
    v_smfmac_f32_32x32x32_bf16 v[84:99], v[44:47], v[68:75], v100
    s_waitcnt lgkmcnt(0)
    ds_read_b128 v[40:43], v102 offset:53344
    v_exp_f32 v80, v80
    v_exp_f32 v81, v81
    v_exp_f32 v82, v82
    v_exp_f32 v83, v83
    v_exp_f32 v52, v52
    v_exp_f32 v53, v53
    v_smfmac_f32_32x32x32_bf16 v[84:99], v[48:51], v[76:83], v100
    ds_read_b128 v[44:47], v102 offset:54912
    v_exp_f32 v54, v54
    v_exp_f32 v55, v55
    v_exp_f32 v56, v56
    v_exp_f32 v57, v57
    v_mfma_f32_32x32x16_bf16 v[68:83], v[32:35], v[8:11], v[12:27]
    ds_read_b128 v[28:31], v101 offset:57024
    v_exp_f32 v58, v58
    v_exp_f32 v59, v59
    v_exp_f32 v60, v60
    v_exp_f32 v61, v61
    v_exp_f32 v62, v62
    v_exp_f32 v63, v63
    v_smfmac_f32_32x32x32_bf16 v[84:99], v[36:39], v[52:59], v100
    s_waitcnt lgkmcnt(0)
    ds_read_b128 v[48:51], v102 offset:55456
    v_exp_f32 v64, v64
    v_exp_f32 v65, v65
    v_exp_f32 v66, v66
    v_exp_f32 v67, v67
    v_exp_f32 v68, v68
    v_exp_f32 v69, v69
    v_smfmac_f32_32x32x32_bf16 v[84:99], v[40:43], v[60:67], v100
    ds_read_b128 v[36:39], v102 offset:57024
    v_exp_f32 v70, v70
    v_exp_f32 v71, v71
    v_exp_f32 v72, v72
    v_exp_f32 v73, v73
    v_mfma_f32_32x32x16_bf16 v[52:67], v[28:31], v[8:11], v[12:27]
    ds_read_b128 v[32:35], v101 offset:59136
    v_exp_f32 v74, v74
    v_exp_f32 v75, v75
    v_exp_f32 v76, v76
    v_exp_f32 v77, v77
    v_exp_f32 v78, v78
    v_exp_f32 v79, v79
    v_smfmac_f32_32x32x32_bf16 v[84:99], v[44:47], v[68:75], v100
    s_waitcnt lgkmcnt(0)
    ds_read_b128 v[40:43], v102 offset:57568
    v_exp_f32 v80, v80
    v_exp_f32 v81, v81
    v_exp_f32 v82, v82
    v_exp_f32 v83, v83
    v_exp_f32 v52, v52
    v_exp_f32 v53, v53
    v_smfmac_f32_32x32x32_bf16 v[84:99], v[48:51], v[76:83], v100
    ds_read_b128 v[44:47], v102 offset:59136
    v_exp_f32 v54, v54
    v_exp_f32 v55, v55
    v_exp_f32 v56, v56
    v_exp_f32 v57, v57
    v_mfma_f32_32x32x16_bf16 v[68:83], v[32:35], v[8:11], v[12:27]
    ds_read_b128 v[28:31], v101 offset:61248
    buffer_load_dwordx4 v[248:251], v1, s[36:39], s66 offen
    v_exp_f32 v58, v58
    v_exp_f32 v59, v59
    v_exp_f32 v60, v60
    v_exp_f32 v61, v61
    v_exp_f32 v62, v62
    v_exp_f32 v63, v63
    v_smfmac_f32_32x32x32_bf16 v[84:99], v[36:39], v[52:59], v100
    s_waitcnt lgkmcnt(0)
    ds_read_b128 v[48:51], v102 offset:59680
    v_exp_f32 v64, v64
    v_exp_f32 v65, v65
    v_exp_f32 v66, v66
    v_exp_f32 v67, v67
    v_exp_f32 v68, v68
    v_exp_f32 v69, v69
    v_smfmac_f32_32x32x32_bf16 v[84:99], v[40:43], v[60:67], v100
    ds_read_b128 v[36:39], v102 offset:61248
    v_exp_f32 v70, v70
    v_exp_f32 v71, v71
    v_exp_f32 v72, v72
    v_exp_f32 v73, v73
    v_mfma_f32_32x32x16_bf16 v[52:67], v[28:31], v[8:11], v[12:27]
    ds_read_b128 v[32:35], v101 offset:63360
    v_exp_f32 v74, v74
    v_exp_f32 v75, v75
    v_exp_f32 v76, v76
    v_exp_f32 v77, v77
    v_exp_f32 v78, v78
    v_exp_f32 v79, v79
    v_smfmac_f32_32x32x32_bf16 v[84:99], v[44:47], v[68:75], v100
    s_waitcnt lgkmcnt(0)
    ds_read_b128 v[40:43], v102 offset:61792
    v_exp_f32 v80, v80
    v_exp_f32 v81, v81
    v_exp_f32 v82, v82
    v_exp_f32 v83, v83
    v_add_u32 v101, 61248, v101
    v_add_u32 v102, 61248, v102
    v_exp_f32 v52, v52
    v_exp_f32 v53, v53
    v_smfmac_f32_32x32x32_bf16 v[84:99], v[48:51], v[76:83], v100
    ds_read_b128 v[44:47], v102 offset:2112
    v_exp_f32 v54, v54
    v_exp_f32 v55, v55
    v_exp_f32 v56, v56
    v_exp_f32 v57, v57
    v_mfma_f32_32x32x16_bf16 v[68:83], v[32:35], v[8:11], v[12:27]
    ds_read_b128 v[28:31], v101 offset:4224
    v_exp_f32 v58, v58
    v_exp_f32 v59, v59
    v_exp_f32 v60, v60
    v_exp_f32 v61, v61
    v_exp_f32 v62, v62
    v_exp_f32 v63, v63
    v_smfmac_f32_32x32x32_bf16 v[84:99], v[36:39], v[52:59], v100
    s_waitcnt lgkmcnt(0)
    ds_read_b128 v[48:51], v102 offset:2656
    v_exp_f32 v64, v64
    v_exp_f32 v65, v65
    v_exp_f32 v66, v66
    v_exp_f32 v67, v67
    v_exp_f32 v68, v68
    v_exp_f32 v69, v69
    v_smfmac_f32_32x32x32_bf16 v[84:99], v[40:43], v[60:67], v100
    ds_read_b128 v[36:39], v102 offset:4224
    v_exp_f32 v70, v70
    v_exp_f32 v71, v71
    v_exp_f32 v72, v72
    v_exp_f32 v73, v73
    v_mfma_f32_32x32x16_bf16 v[52:67], v[28:31], v[8:11], v[12:27]
    ds_read_b128 v[32:35], v101 offset:6336
    v_exp_f32 v74, v74
    v_exp_f32 v75, v75
    v_exp_f32 v76, v76
    v_exp_f32 v77, v77
    v_exp_f32 v78, v78
    v_exp_f32 v79, v79
    v_smfmac_f32_32x32x32_bf16 v[84:99], v[44:47], v[68:75], v100
    s_waitcnt lgkmcnt(0)
    ds_read_b128 v[40:43], v102 offset:4768
    v_exp_f32 v80, v80
    v_exp_f32 v81, v81
    v_exp_f32 v82, v82
    v_exp_f32 v83, v83
    v_exp_f32 v52, v52
    v_exp_f32 v53, v53
    v_smfmac_f32_32x32x32_bf16 v[84:99], v[48:51], v[76:83], v100
    ds_read_b128 v[44:47], v102 offset:6336
    v_exp_f32 v54, v54
    v_exp_f32 v55, v55
    v_exp_f32 v56, v56
    v_exp_f32 v57, v57
    v_mfma_f32_32x32x16_bf16 v[68:83], v[32:35], v[8:11], v[12:27]
    ds_read_b128 v[28:31], v101 offset:8448
    buffer_load_dwordx4 v[252:255], v1, s[36:39], s67 offen
    v_exp_f32 v58, v58
    v_exp_f32 v59, v59
    v_exp_f32 v60, v60
    v_exp_f32 v61, v61
    v_exp_f32 v62, v62
    v_exp_f32 v63, v63
    v_smfmac_f32_32x32x32_bf16 v[84:99], v[36:39], v[52:59], v100
    s_waitcnt lgkmcnt(0)
    ds_read_b128 v[48:51], v102 offset:6880
    v_exp_f32 v64, v64
    v_exp_f32 v65, v65
    v_exp_f32 v66, v66
    v_exp_f32 v67, v67
    v_exp_f32 v68, v68
    v_exp_f32 v69, v69
    v_smfmac_f32_32x32x32_bf16 v[84:99], v[40:43], v[60:67], v100
    ds_read_b128 v[36:39], v102 offset:8448
    v_exp_f32 v70, v70
    v_exp_f32 v71, v71
    v_exp_f32 v72, v72
    v_exp_f32 v73, v73
    v_mfma_f32_32x32x16_bf16 v[52:67], v[28:31], v[8:11], v[12:27]
    ds_read_b128 v[32:35], v101 offset:10560
    v_exp_f32 v74, v74
    v_exp_f32 v75, v75
    v_exp_f32 v76, v76
    v_exp_f32 v77, v77
    v_exp_f32 v78, v78
    v_exp_f32 v79, v79
    v_smfmac_f32_32x32x32_bf16 v[84:99], v[44:47], v[68:75], v100
    s_waitcnt lgkmcnt(0)
    ds_read_b128 v[40:43], v102 offset:8992
    v_exp_f32 v80, v80
    v_exp_f32 v81, v81
    v_exp_f32 v82, v82
    v_exp_f32 v83, v83
    v_exp_f32 v52, v52
    v_exp_f32 v53, v53
    v_smfmac_f32_32x32x32_bf16 v[84:99], v[48:51], v[76:83], v100
    ds_read_b128 v[44:47], v102 offset:10560
    v_exp_f32 v54, v54
    v_exp_f32 v55, v55
    v_exp_f32 v56, v56
    v_exp_f32 v57, v57
    v_mfma_f32_32x32x16_bf16 v[68:83], v[32:35], v[8:11], v[12:27]
    v_exp_f32 v58, v58
    v_exp_f32 v59, v59
    v_exp_f32 v60, v60
    v_exp_f32 v61, v61
    v_exp_f32 v62, v62
    v_exp_f32 v63, v63
    v_smfmac_f32_32x32x32_bf16 v[84:99], v[36:39], v[52:59], v100
    s_waitcnt lgkmcnt(0)
    ds_read_b128 v[48:51], v102 offset:11104
    v_exp_f32 v64, v64
    v_exp_f32 v65, v65
    v_exp_f32 v66, v66
    v_exp_f32 v67, v67
    v_exp_f32 v68, v68
    v_exp_f32 v69, v69
    v_smfmac_f32_32x32x32_bf16 v[84:99], v[40:43], v[60:67], v100
    v_exp_f32 v70, v70
    v_exp_f32 v71, v71
    v_exp_f32 v72, v72
    v_exp_f32 v73, v73
    v_exp_f32 v74, v74
    v_exp_f32 v75, v75
    v_exp_f32 v76, v76
    v_exp_f32 v77, v77
    v_exp_f32 v78, v78
    v_exp_f32 v79, v79
    v_smfmac_f32_32x32x32_bf16 v[84:99], v[44:47], v[68:75], v100
    s_waitcnt lgkmcnt(0)
    v_exp_f32 v80, v80
    v_exp_f32 v81, v81
    v_exp_f32 v82, v82
    v_exp_f32 v83, v83
    s_nop 1
    v_smfmac_f32_32x32x32_bf16 v[84:99], v[48:51], v[76:83], v100
    s_mov_b32 s48, 0x76800000
    s_mov_b32 s12, 0xb800000
    v_and_b32 v4, 7, v5
    v_mul_u32_u24 v4, 1040, v4
    v_lshrrev_b32 v7, 3, v5
    v_lshl_add_u32 v4, v7, 5, v4
    v_lshl_add_u32 v4, v6, 3, v4
    s_lshl_b32 s49, s40, 7
    s_add_u32 s49, s49, 135168
    v_add_u32 v4, s49, v4
    v_and_b32 v1, 7, v2
    v_mul_u32_u24 v0, 1040, v1
    v_lshrrev_b32 v7, 4, v2
    v_mul_f32 v3, 0, v84
    v_fma_f32 v3, v85, 0, v3
    v_fma_f32 v3, v86, 0, v3
    v_fma_f32 v3, v87, 0, v3
    v_fma_f32 v3, v88, 0, v3
    v_fma_f32 v3, v89, 0, v3
    v_fma_f32 v3, v90, 0, v3
    v_fma_f32 v3, v91, 0, v3
    v_add_f32 v3, v3, v92
    v_cmp_ngt_f32 vcc, s48, v3
    v_cmp_gt_f32 s[62:63], s12, v3
    v_rcp_f32 v3, v92
    s_or_b64 vcc, vcc, s[62:63]
    s_cbranch_scc1 L2_slow
L2_epi:
    v_mul_f32 v84, v3, v84
    v_mul_f32 v85, v3, v85
    v_mul_f32 v86, v3, v86
    v_mul_f32 v87, v3, v87
    v_mul_f32 v88, v3, v88
    v_mul_f32 v89, v3, v89
    v_mul_f32 v90, v3, v90
    v_mul_f32 v91, v3, v91
    v_cvt_pk_bf16_f32 v84, v84, v85
    v_cvt_pk_bf16_f32 v85, v86, v87
    v_cvt_pk_bf16_f32 v86, v88, v89
    v_cvt_pk_bf16_f32 v87, v90, v91
    ds_write_b64 v4, v[84:85]
    ds_write_b64 v4, v[86:87] offset:16
    v_lshl_add_u32 v101, v7, 5, v0
    v_and_b32 v3, 8, v2
    v_lshl_add_u32 v101, v3, 1, v101
    v_add_u32 v101, 135168, v101
    v_cmp_ne_u32 vcc, 0, v3
    v_mov_b32 v100, 0x4444
    v_mov_b32 v3, 0xeeee
    s_and_b32 s49, s40, 3
    s_lshl_b32 s49, s49, 12
    s_add_u32 s49, s49, 144512
    v_add_u32 v102, s49, v103
    v_cndmask_b32 v100, v100, v3, vcc
    s_waitcnt vmcnt(3)
    s_cmp_lt_u32 s40, 4
    s_cbranch_scc1 L2_old
L2_join:
    v_lshlrev_b32 v60, 16, v236
    v_and_b32 v61, 0xffff0000, v236
    v_lshlrev_b32 v52, 16, v240
    v_and_b32 v53, 0xffff0000, v240
    v_lshlrev_b32 v62, 16, v237
    v_and_b32 v63, 0xffff0000, v237
    v_lshlrev_b32 v54, 16, v241
    v_and_b32 v55, 0xffff0000, v241
    v_lshlrev_b32 v64, 16, v238
    v_and_b32 v65, 0xffff0000, v238
    v_lshlrev_b32 v56, 16, v242
    v_and_b32 v57, 0xffff0000, v242
    v_lshlrev_b32 v66, 16, v239
    v_and_b32 v67, 0xffff0000, v239
    v_lshlrev_b32 v58, 16, v243
    v_and_b32 v59, 0xffff0000, v243
    v_add_f32 v71, v52, v53
    v_add_f32 v71, v71, v54
    v_add_f32 v71, v71, v55
    v_add_f32 v71, v71, v56
    v_add_f32 v71, v71, v57
    v_add_f32 v71, v71, v58
    v_add_f32 v71, v71, v59
    v_mov_b32 v7, 0x3f803f80
    v_lshrrev_b32 v106, 10, v104
    v_lshlrev_b32 v4, 5, v106
    v_add_u32 v4, 143488, v4
    v_lshrrev_b32 v3, 5, v2
    v_lshl_add_u32 v3, v3, 9, v4
    s_lshl_b32 s49, s40, 2
    v_add_u32 v3, s49, v3
    v_add_u32 v0, s45, v103
    s_add_u32 s49, s44, 4194304
    s_cmp_ge_u32 s40, 4
    s_cselect_b64 s[62:63], -1, 0
    s_waitcnt lgkmcnt(0)
    s_barrier
    s_mov_b64 exec, s[62:63]
    ds_read_b128 v[84:87], v102 offset:0
    ds_read_b128 v[88:91], v102 offset:1024
    ds_read_b128 v[92:95], v102 offset:2048
    ds_read_b128 v[96:99], v102 offset:3072
    s_mov_b64 exec, -1
    ds_read_b128 v[8:11], v101 offset:512
    ds_read_b128 v[28:31], v101 offset:640
    ds_read_b128 v[32:35], v101 offset:768
    ds_read_b128 v[36:39], v101 offset:896
    s_waitcnt lgkmcnt(3)
    v_smfmac_f32_16x16x64_bf16 v[84:87], v[8:11], v[108:115], v100
    v_smfmac_f32_16x16x64_bf16 v[88:91], v[8:11], v[116:123], v100
    v_smfmac_f32_16x16x64_bf16 v[92:95], v[8:11], v[124:131], v100
    v_smfmac_f32_16x16x64_bf16 v[96:99], v[8:11], v[132:139], v100
    s_waitcnt lgkmcnt(2)
    v_smfmac_f32_16x16x64_bf16 v[84:87], v[28:31], v[140:147], v100
    v_smfmac_f32_16x16x64_bf16 v[88:91], v[28:31], v[148:155], v100
    v_smfmac_f32_16x16x64_bf16 v[92:95], v[28:31], v[156:163], v100
    v_smfmac_f32_16x16x64_bf16 v[96:99], v[28:31], v[164:171], v100
    s_waitcnt lgkmcnt(1)
    v_smfmac_f32_16x16x64_bf16 v[84:87], v[32:35], v[172:179], v100
    v_smfmac_f32_16x16x64_bf16 v[88:91], v[32:35], v[180:187], v100
    v_smfmac_f32_16x16x64_bf16 v[92:95], v[32:35], v[188:195], v100
    v_smfmac_f32_16x16x64_bf16 v[96:99], v[32:35], v[196:203], v100
    s_waitcnt lgkmcnt(0)
    v_smfmac_f32_16x16x64_bf16 v[84:87], v[36:39], v[204:211], v100
    v_smfmac_f32_16x16x64_bf16 v[88:91], v[36:39], v[212:219], v100
    v_smfmac_f32_16x16x64_bf16 v[92:95], v[36:39], v[220:227], v100
    v_smfmac_f32_16x16x64_bf16 v[96:99], v[36:39], v[228:235], v100
    s_waitcnt vmcnt(0)
    ds_write_b128 v0, v[244:247] offset:0
    ds_write_b128 v0, v[248:251] offset:8192
    ds_write_b128 v0, v[252:255] offset:16384
    s_mov_b32 vcc_lo, 0x55555555
    s_mov_b32 vcc_hi, 0x55555555
    s_nop 1
    v_permlane32_swap_b32 v84, v88
    v_permlane32_swap_b32 v85, v89
    v_permlane32_swap_b32 v86, v90
    v_permlane32_swap_b32 v87, v91
    v_permlane32_swap_b32 v92, v96
    v_permlane32_swap_b32 v93, v97
    v_permlane32_swap_b32 v94, v98
    v_permlane32_swap_b32 v95, v99
    v_add_f32 v60, v60, v84
    v_add_f32 v61, v61, v92
    v_add_f32 v62, v62, v85
    v_add_f32 v63, v63, v93
    v_add_f32 v64, v64, v86
    v_add_f32 v65, v65, v94
    v_add_f32 v66, v66, v87
    v_add_f32 v67, v67, v95
    v_add_f32 v60, v60, v88
    v_add_f32 v61, v61, v96
    v_add_f32 v62, v62, v89
    v_add_f32 v63, v63, v97
    v_add_f32 v64, v64, v90
    v_add_f32 v65, v65, v98
    v_add_f32 v66, v66, v91
    v_add_f32 v67, v67, v99
    v_cvt_pk_bf16_f32 v40, v60, v61
    v_cvt_pk_bf16_f32 v41, v62, v63
    v_cvt_pk_bf16_f32 v42, v64, v65
    v_cvt_pk_bf16_f32 v43, v66, v67
    s_nop 0
    v_cndmask_b32_dpp v44, v41, v40, vcc quad_perm:[1,0,3,2] row_mask:0xf bank_mask:0xf
    v_cndmask_b32_dpp v46, v43, v42, vcc quad_perm:[1,0,3,2] row_mask:0xf bank_mask:0xf
    s_not_b64 vcc, vcc
    v_cndmask_b32_dpp v45, v40, v41, vcc quad_perm:[1,0,3,2] row_mask:0xf bank_mask:0xf
    v_cndmask_b32_dpp v47, v42, v43, vcc quad_perm:[1,0,3,2] row_mask:0xf bank_mask:0xf
    s_mov_b32 vcc_lo, 0x33333333
    s_mov_b32 vcc_hi, 0x33333333
    v_cndmask_b32_dpp v48, v46, v44, vcc quad_perm:[2,3,0,1] row_mask:0xf bank_mask:0xf
    v_cndmask_b32_dpp v49, v47, v45, vcc quad_perm:[2,3,0,1] row_mask:0xf bank_mask:0xf
    s_not_b64 vcc, vcc
    v_cndmask_b32_dpp v50, v44, v46, vcc quad_perm:[2,3,0,1] row_mask:0xf bank_mask:0xf
    v_cndmask_b32_dpp v51, v45, v47, vcc quad_perm:[2,3,0,1] row_mask:0xf bank_mask:0xf
    buffer_store_dwordx4 v[48:51], v104, s[28:31], s49 offen sc0 sc1
    v_lshlrev_b32 v60, 16, v48
    v_and_b32 v61, 0xffff0000, v48
    v_lshlrev_b32 v62, 16, v49
    v_and_b32 v63, 0xffff0000, v49
    v_lshlrev_b32 v64, 16, v50
    v_and_b32 v65, 0xffff0000, v50
    v_lshlrev_b32 v66, 16, v51
    v_and_b32 v67, 0xffff0000, v51
    v_add_f32 v68, v60, v61
    v_mul_f32 v69, v60, v60
    v_mul_f32 v70, v60, v52
    v_fmac_f32 v69, v61, v61
    v_fmac_f32 v70, v61, v53
    v_add_f32 v68, v68, v62
    v_fmac_f32 v69, v62, v62
    v_fmac_f32 v70, v62, v54
    v_add_f32 v68, v68, v63
    v_fmac_f32 v69, v63, v63
    v_fmac_f32 v70, v63, v55
    v_add_f32 v68, v68, v64
    v_fmac_f32 v69, v64, v64
    v_fmac_f32 v70, v64, v56
    v_add_f32 v68, v68, v65
    v_fmac_f32 v69, v65, v65
    v_fmac_f32 v70, v65, v57
    v_add_f32 v68, v68, v66
    v_fmac_f32 v69, v66, v66
    v_fmac_f32 v70, v66, v58
    v_add_f32 v68, v68, v67
    v_fmac_f32 v69, v67, v67
    v_fmac_f32 v70, v67, v59
    s_nop 0
    v_permlane32_swap_b32 v68, v69
    v_permlane32_swap_b32 v70, v71
    v_add_f32 v68, v68, v69
    v_add_f32 v70, v70, v71
    s_nop 0
    v_add_f32_dpp v68, v68, v68 row_ror:8 row_mask:0xf bank_mask:0xf
    v_add_f32_dpp v70, v70, v70 row_ror:8 row_mask:0xf bank_mask:0xf
    s_nop 0
    v_add_f32_dpp v68, v68, v68 row_ror:4 row_mask:0xf bank_mask:0xf
    v_add_f32_dpp v70, v70, v70 row_ror:4 row_mask:0xf bank_mask:0xf
    ds_write_b32 v3, v68
    ds_write_b32 v3, v70 offset:256
    s_waitcnt lgkmcnt(0)
    s_barrier
    ds_read_b128 v[108:111], v4 offset:0
    ds_read_b128 v[112:115], v4 offset:16
    ds_read_b128 v[124:127], v4 offset:512
    ds_read_b128 v[128:131], v4 offset:528
    ds_read_b128 v[116:119], v4 offset:256
    ds_read_b128 v[120:123], v4 offset:272
    ds_read_b128 v[132:135], v4 offset:768
    ds_read_b128 v[136:139], v4 offset:784
    s_waitcnt lgkmcnt(4)
    v_add_f32 v108, v108, v109
    v_add_f32 v110, v110, v111
    v_add_f32 v112, v112, v113
    v_add_f32 v114, v114, v115
    v_add_f32 v108, v108, v110
    v_add_f32 v112, v112, v114
    v_add_f32 v108, v108, v112
    v_add_f32 v124, v124, v125
    v_add_f32 v126, v126, v127
    v_add_f32 v128, v128, v129
    v_add_f32 v130, v130, v131
    v_add_f32 v124, v124, v126
    v_add_f32 v128, v128, v130
    v_add_f32 v124, v124, v128
    v_mul_f32 v76, 0x3b000000, v108
    v_mul_f32 v124, 0x3b000000, v124
    v_fma_f32 v124, -v76, v76, v124
    v_max_f32 v124, 0, v124
    v_add_f32 v124, 0x3727c5ac, v124
    v_rsq_f32 v77, v124
    s_cmp_lg_u32 s40, 0
    s_cbranch_scc1 L2_nokey
    s_waitcnt lgkmcnt(0)
    v_add_f32 v116, v116, v117
    v_add_f32 v118, v118, v119
    v_add_f32 v120, v120, v121
    v_add_f32 v122, v122, v123
    v_add_f32 v116, v116, v118
    v_add_f32 v120, v120, v122
    v_add_f32 v116, v116, v120
    v_add_f32 v132, v132, v133
    v_add_f32 v134, v134, v135
    v_add_f32 v136, v136, v137
    v_add_f32 v138, v138, v139
    v_add_f32 v132, v132, v134
    v_add_f32 v136, v136, v138
    v_add_f32 v132, v132, v136
    v_fma_f32 v116, -v76, v132, v116
    s_lshl_b32 s48, s41, 3
    v_add_u32 v4, s48, v106
    v_mul_f32 v78, v77, v116
    v_mov_b32 v79, s68
    v_lshlrev_b32 v0, 4, v4
    s_mov_b32 s48, 6356992
    s_mov_b64 exec, 0x000f000f
    buffer_store_dwordx4 v[76:79], v0, s[28:31], s48 offen sc0 sc1
    s_mov_b64 exec, -1
    v_ashrrev_i32 v3, 31, v78
    v_or_b32 v3, 0x80000000, v3
    v_xor_b32 v3, v3, v78
    v_and_b32 v3, 0xfffff800, v3
    v_sub_u32 v4, 2047, v4
    v_or_b32 v4, v3, v4
    s_lshl_b32 s48, s2, 5
    s_add_u32 s48, s48, 6488064
    v_mov_b32_dpp v6, v4 quad_perm:[1,0,3,2] row_mask:0xf bank_mask:0xf
    v_mov_b32 v0, 0
    v_min_u32 v5, v4, v6
    v_max_u32 v4, v4, v6
    s_nop 0
    v_mov_b32_dpp v3, v5 quad_perm:[2,3,0,1] row_mask:0xf bank_mask:0xf
    v_mov_b32_dpp v6, v4 quad_perm:[2,3,0,1] row_mask:0xf bank_mask:0xf
    v_max_u32 v5, v5, v3
    v_med3_u32 v5, v4, v5, v6
    v_max_u32 v4, v4, v6
    v_mov_b32 v3, v5
    v_mov_b32 v6, v4
    s_nop 0
    v_permlane16_swap_b32 v5, v3
    v_permlane16_swap_b32 v4, v6
    v_max_u32 v5, v5, v3
    v_med3_u32 v5, v4, v5, v6
    v_max_u32 v4, v4, v6
    s_waitcnt vmcnt(1)
    s_barrier
    s_mov_b64 exec, 1
    buffer_store_dwordx2 v[4:5], v0, s[28:31], s48 offen sc0 sc1
    s_mov_b64 exec, -1
    v_lshlrev_b32 v8, 5, v2
    s_mov_b32 s48, 6488064
    s_mov_b32 s56, 6488064
    s_mov_b32 s57, 6490112
    s_mov_b32 s58, 6492160
    s_mov_b32 s59, 6494208
    v_and_b32 v9, 15, v2
    v_lshrrev_b32 v11, 4, v2
    v_lshrrev_b32 v10, 2, v9
    v_lshl_add_u32 v10, v11, 7, v10
    v_lshlrev_b32 v10, 4, v10
    v_and_b32 v0, 1, v9
    v_lshl_add_u32 v10, v0, 3, v10
    v_and_b32 v3, 2, v9
    v_lshl_add_u32 v10, v3, 12, v10
    ds_read_b64_tr_b16 v[140:141], v10 offset:0
    ds_read_b64_tr_b16 v[142:143], v10 offset:64
    ds_read_b64_tr_b16 v[144:145], v10 offset:128
    ds_read_b64_tr_b16 v[146:147], v10 offset:192
    ds_read_b64_tr_b16 v[148:149], v10 offset:256
    ds_read_b64_tr_b16 v[150:151], v10 offset:320
    ds_read_b64_tr_b16 v[152:153], v10 offset:384
    ds_read_b64_tr_b16 v[154:155], v10 offset:448
    ds_read_b64_tr_b16 v[156:157], v10 offset:512
    ds_read_b64_tr_b16 v[158:159], v10 offset:576
    ds_read_b64_tr_b16 v[160:161], v10 offset:640
    ds_read_b64_tr_b16 v[162:163], v10 offset:704
    ds_read_b64_tr_b16 v[164:165], v10 offset:768
    ds_read_b64_tr_b16 v[166:167], v10 offset:832
    v_add_f32 v3, 1.0, v77
    v_mul_f32 v6, v76, v77
    v_fma_f32 v40, v60, v3, -v6
    v_fma_f32 v41, v61, v3, -v6
    v_fma_f32 v42, v62, v3, -v6
    v_fma_f32 v43, v63, v3, -v6
    v_fma_f32 v44, v64, v3, -v6
    v_fma_f32 v45, v65, v3, -v6
    v_fma_f32 v46, v66, v3, -v6
    v_fma_f32 v47, v67, v3, -v6
    v_cvt_pk_bf16_f32 v80, v40, v41
    v_cvt_pk_bf16_f32 v81, v42, v43
    v_cvt_pk_bf16_f32 v82, v44, v45
    v_cvt_pk_bf16_f32 v83, v46, v47
    s_waitcnt lgkmcnt(0)
    ds_read_b64_tr_b16 v[168:169], v10 offset:896
    ds_read_b64_tr_b16 v[170:171], v10 offset:960
    ds_read_b64_tr_b16 v[172:173], v10 offset:1024
    ds_read_b64_tr_b16 v[174:175], v10 offset:1088
    ds_read_b64_tr_b16 v[176:177], v10 offset:1152
    ds_read_b64_tr_b16 v[178:179], v10 offset:1216
    ds_read_b64_tr_b16 v[180:181], v10 offset:1280
    ds_read_b64_tr_b16 v[182:183], v10 offset:1344
    ds_read_b64_tr_b16 v[184:185], v10 offset:1408
    ds_read_b64_tr_b16 v[186:187], v10 offset:1472
    ds_read_b64_tr_b16 v[188:189], v10 offset:1536
    ds_read_b64_tr_b16 v[190:191], v10 offset:1600
    ds_read_b64_tr_b16 v[192:193], v10 offset:1664
    ds_read_b64_tr_b16 v[194:195], v10 offset:1728
    v_mov_b32 v252, v7
    v_mov_b32 v253, v7
    v_mov_b32 v254, v7
    v_mov_b32 v255, v7
    s_waitcnt lgkmcnt(4)
    ds_read_b64_tr_b16 v[196:197], v10 offset:1792
    ds_read_b64_tr_b16 v[198:199], v10 offset:1856
    ds_read_b64_tr_b16 v[200:201], v10 offset:1920
    ds_read_b64_tr_b16 v[202:203], v10 offset:1984
    s_waitcnt vmcnt(0)
    buffer_load_dwordx2 v[128:129], v8, s[28:31], s56 offen sc1
    buffer_load_dwordx2 v[130:131], v8, s[28:31], s57 offen sc1
    buffer_load_dwordx2 v[132:133], v8, s[28:31], s58 offen sc1
    buffer_load_dwordx2 v[134:135], v8, s[28:31], s59 offen sc1
    v_cmp_eq_u32 s[10:11], 1, v0
    v_mul_u32_u24 v10, 1040, v0
    v_lshl_add_u32 v10, v11, 8, v10
    v_lshlrev_b32 v108, 4, v0
    v_lshl_add_u32 v108, v11, 3, v108
    s_mov_b32 s49, 0
    s_mov_b32 s46, 0
    s_mov_b32 s47, 0
    s_mov_b32 s51, 6356992
    s_waitcnt lgkmcnt(0)
    v_mfma_f32_16x16x32_bf16 v[212:215], v[140:143], v[252:255], 0
    v_mfma_f32_16x16x32_bf16 v[212:215], v[144:147], v[252:255], v[212:215]
    v_mfma_f32_16x16x32_bf16 v[212:215], v[148:151], v[252:255], v[212:215]
    v_mfma_f32_16x16x32_bf16 v[212:215], v[152:155], v[252:255], v[212:215]
    v_mfma_f32_16x16x32_bf16 v[212:215], v[156:159], v[252:255], v[212:215]
    v_mfma_f32_16x16x32_bf16 v[212:215], v[160:163], v[252:255], v[212:215]
    v_mfma_f32_16x16x32_bf16 v[212:215], v[164:167], v[252:255], v[212:215]
    v_mfma_f32_16x16x32_bf16 v[212:215], v[168:171], v[252:255], v[212:215]
    v_mfma_f32_16x16x32_bf16 v[212:215], v[172:175], v[252:255], v[212:215]
    v_mfma_f32_16x16x32_bf16 v[212:215], v[176:179], v[252:255], v[212:215]
    v_mfma_f32_16x16x32_bf16 v[212:215], v[180:183], v[252:255], v[212:215]
    v_mfma_f32_16x16x32_bf16 v[212:215], v[184:187], v[252:255], v[212:215]
    v_mfma_f32_16x16x32_bf16 v[212:215], v[188:191], v[252:255], v[212:215]
    v_mfma_f32_16x16x32_bf16 v[212:215], v[192:195], v[252:255], v[212:215]
    v_mfma_f32_16x16x32_bf16 v[212:215], v[196:199], v[252:255], v[212:215]
    v_mfma_f32_16x16x32_bf16 v[212:215], v[200:203], v[252:255], v[212:215]
L2_kpoll:
    s_waitcnt vmcnt(0)
    v_min_u32 v0, v128, v130
    v_min3_u32 v0, v132, v134, v0
    v_cmp_eq_u32 s[62:63], 0, v0
    s_add_u32 s49, s49, 1
    s_cmp_gt_u32 s49, 0x40000
    s_cselect_b64 s[62:63], 0, s[62:63]
    v_max_u32 v4, v128, v130
    v_min_u32 v5, v128, v130
    v_max3_u32 v5, v5, v129, v131
    v_med3_u32 v5, v4, v5, v132
    v_max_u32 v4, v4, v132
    v_med3_u32 v5, v4, v5, v134
    v_max_u32 v4, v4, v134
    v_max3_u32 v5, v5, v133, v135
    s_mov_b64 exec, s[62:63]
    s_cbranch_execz L2_klast
    buffer_load_dwordx2 v[128:129], v8, s[28:31], s56 offen sc1
    buffer_load_dwordx2 v[130:131], v8, s[28:31], s57 offen sc1
    buffer_load_dwordx2 v[132:133], v8, s[28:31], s58 offen sc1
    buffer_load_dwordx2 v[134:135], v8, s[28:31], s59 offen sc1
L2_klast:
    s_mov_b64 exec, -1
    v_mov_b32_dpp v3, v5 quad_perm:[1,0,3,2] row_mask:0xf bank_mask:0xf
    v_mov_b32_dpp v6, v4 quad_perm:[1,0,3,2] row_mask:0xf bank_mask:0xf
    v_max_u32 v5, v5, v3
    v_med3_u32 v5, v4, v5, v6
    v_max_u32 v4, v4, v6
    s_nop 0
    v_mov_b32_dpp v3, v5 quad_perm:[2,3,0,1] row_mask:0xf bank_mask:0xf
    v_mov_b32_dpp v6, v4 quad_perm:[2,3,0,1] row_mask:0xf bank_mask:0xf
    v_max_u32 v5, v5, v3
    v_med3_u32 v5, v4, v5, v6
    v_max_u32 v4, v4, v6
    s_nop 0
    v_mov_b32_dpp v3, v5 row_half_mirror row_mask:0xf bank_mask:0xf
    v_mov_b32_dpp v6, v4 row_half_mirror row_mask:0xf bank_mask:0xf
    v_max_u32 v5, v5, v3
    v_med3_u32 v5, v4, v5, v6
    v_max_u32 v4, v4, v6
    s_nop 0
    v_mov_b32_dpp v3, v5 row_mirror row_mask:0xf bank_mask:0xf
    v_mov_b32_dpp v6, v4 row_mirror row_mask:0xf bank_mask:0xf
    v_max_u32 v5, v5, v3
    v_med3_u32 v5, v4, v5, v6
    v_max_u32 v4, v4, v6
    s_nop 0
    v_mov_b32 v3, v5
    v_mov_b32 v6, v4
    s_nop 0
    v_permlane16_swap_b32 v5, v3
    v_permlane16_swap_b32 v4, v6
    v_max_u32 v5, v5, v3
    v_med3_u32 v5, v4, v5, v6
    v_max_u32 v4, v4, v6
    v_mov_b32 v3, v5
    v_mov_b32 v6, v4
    s_nop 0
    v_permlane32_swap_b32 v5, v3
    v_permlane32_swap_b32 v4, v6
    v_max_u32 v5, v5, v3
    v_med3_u32 v5, v4, v5, v6
    v_max_u32 v4, v4, v6
    v_readfirstlane_b32 s53, v5
    v_readfirstlane_b32 s52, v4
    v_cndmask_b32 v3, v4, v5, s[10:11]
    v_not_b32 v3, v3
    s_cmp_eq_u64 s[52:53], s[46:47]
    s_cbranch_scc1 L2_ksame
    s_mov_b64 s[46:47], s[52:53]
    s_cmp_ge_u32 s2, 176
    s_cbranch_scc1 L2_ksame
    s_andn2_b32 s54, 0x7ff, s52
    s_andn2_b32 s55, 0x7ff, s53
    s_lshl_b32 s54, s54, 10
    s_lshl_b32 s55, s55, 10
    s_add_u32 s54, s54, 4194304
    s_add_u32 s55, s55, 4194304
    s_mov_b32 m0, 40960
    v_and_b32 v3, 0x7ff, v3
    buffer_load_dwordx4 v103, s[28:31], s54 offen sc1 lds
    s_mov_b32 m0, 42000
    v_lshlrev_b32 v9, 4, v3
    buffer_load_dwordx4 v103, s[28:31], s55 offen sc1 lds
    buffer_load_dwordx4 v[204:207], v9, s[28:31], s51 offen sc1
L2_ksame:
    s_cmp_lg_u64 s[62:63], 0
    s_cbranch_scc1 L2_kpoll
    v_mov_b32 v0, 160912
    ds_write_b64 v0, v[4:5]
    s_cmp_ge_u32 s2, 176
    s_cbranch_scc1 L2_bc
    s_cmp_ge_u32 s64, 172
    s_cselect_b32 s48, 0x100000, s64
    s_lshl_b32 s48, s48, 7
    s_add_u32 s48, s48, 6422528
    s_waitcnt vmcnt(1)
    ds_read_b128 v[12:15], v10 offset:40960
    ds_read_b128 v[16:19], v10 offset:40976
    ds_read_b128 v[20:23], v10 offset:40992
    ds_read_b128 v[24:27], v10 offset:41008
    ds_read_b128 v[28:31], v10 offset:41024
    ds_read_b128 v[32:35], v10 offset:41040
    ds_read_b128 v[36:39], v10 offset:41056
    ds_read_b128 v[216:219], v10 offset:41072
    ds_read_b128 v[220:223], v10 offset:41088
    ds_read_b128 v[224:227], v10 offset:41104
    ds_read_b128 v[228:231], v10 offset:41120
    ds_read_b128 v[232:235], v10 offset:41136
    s_waitcnt lgkmcnt(11)
    v_mfma_f32_16x16x32_bf16 v[208:211], v[140:143], v[12:15], 0
    ds_read_b128 v[236:239], v10 offset:41152
    s_waitcnt lgkmcnt(11)
    v_mfma_f32_16x16x32_bf16 v[208:211], v[144:147], v[16:19], v[208:211]
    ds_read_b128 v[240:243], v10 offset:41168
    s_waitcnt lgkmcnt(11)
    v_mfma_f32_16x16x32_bf16 v[208:211], v[148:151], v[20:23], v[208:211]
    ds_read_b128 v[244:247], v10 offset:41184
    s_waitcnt lgkmcnt(11)
    v_mfma_f32_16x16x32_bf16 v[208:211], v[152:155], v[24:27], v[208:211]
    ds_read_b128 v[248:251], v10 offset:41200
    s_waitcnt lgkmcnt(11)
    v_mfma_f32_16x16x32_bf16 v[208:211], v[156:159], v[28:31], v[208:211]
    s_waitcnt lgkmcnt(10)
    v_mfma_f32_16x16x32_bf16 v[208:211], v[160:163], v[32:35], v[208:211]
    s_waitcnt lgkmcnt(9)
    v_mfma_f32_16x16x32_bf16 v[208:211], v[164:167], v[36:39], v[208:211]
    s_waitcnt lgkmcnt(8)
    v_mfma_f32_16x16x32_bf16 v[208:211], v[168:171], v[216:219], v[208:211]
    s_waitcnt lgkmcnt(7)
    v_mfma_f32_16x16x32_bf16 v[208:211], v[172:175], v[220:223], v[208:211]
    s_waitcnt lgkmcnt(6)
    v_mfma_f32_16x16x32_bf16 v[208:211], v[176:179], v[224:227], v[208:211]
    s_waitcnt lgkmcnt(5)
    v_mfma_f32_16x16x32_bf16 v[208:211], v[180:183], v[228:231], v[208:211]
    s_waitcnt lgkmcnt(4)
    v_mfma_f32_16x16x32_bf16 v[208:211], v[184:187], v[232:235], v[208:211]
    s_waitcnt lgkmcnt(3)
    v_mfma_f32_16x16x32_bf16 v[208:211], v[188:191], v[236:239], v[208:211]
    s_waitcnt lgkmcnt(2)
    v_mfma_f32_16x16x32_bf16 v[208:211], v[192:195], v[240:243], v[208:211]
    s_waitcnt lgkmcnt(1)
    v_mfma_f32_16x16x32_bf16 v[208:211], v[196:199], v[244:247], v[208:211]
    s_waitcnt lgkmcnt(0)
    v_mfma_f32_16x16x32_bf16 v[208:211], v[200:203], v[248:251], v[208:211]
L2_stw:
    s_waitcnt vmcnt(0)
    v_cmp_ne_u32 vcc, s68, v207
    s_nop 2
    s_cbranch_vccnz L2_stre
L2_stok:
    s_nop 1
    v_fma_f32 v208, -v204, v212, v208
    v_fma_f32 v209, -v204, v213, v209
    v_fma_f32 v210, -v204, v214, v210
    v_fma_f32 v211, -v204, v215, v211
    v_mul_f32 v208, v208, v205
    v_mul_f32 v209, v209, v205
    v_mul_f32 v210, v210, v205
    v_mul_f32 v211, v211, v205
    v_mov_b32 v120, v208
    v_mov_b32 v121, v209
    v_mov_b32 v122, v210
    v_mov_b32 v123, v211
    v_mul_f32 v116, 0xbfb8aa3b, v208
    v_mul_f32 v117, 0xbfb8aa3b, v209
    v_mul_f32 v118, 0xbfb8aa3b, v210
    v_mul_f32 v119, 0xbfb8aa3b, v211
    v_exp_f32 v116, v116
    v_exp_f32 v117, v117
    v_exp_f32 v118, v118
    v_exp_f32 v119, v119
    v_permlane32_swap_b32 v208, v120
    v_permlane32_swap_b32 v209, v121
    v_permlane32_swap_b32 v210, v122
    v_permlane32_swap_b32 v211, v123
    v_add_f32 v116, 1.0, v116
    v_add_f32 v117, 1.0, v117
    v_add_f32 v118, 1.0, v118
    v_add_f32 v119, 1.0, v119
    v_rcp_f32 v116, v116
    v_rcp_f32 v117, v117
    v_rcp_f32 v118, v118
    v_rcp_f32 v119, v119
    v_mul_f32 v208, v208, v120
    v_mul_f32 v209, v209, v121
    v_mul_f32 v210, v210, v122
    v_mul_f32 v211, v211, v123
    v_mul_f32 v208, v208, v116
    v_mul_f32 v209, v209, v117
    v_mul_f32 v210, v210, v118
    v_mul_f32 v211, v211, v119
    v_cvt_pk_bf16_f32 v110, v208, v209
    v_cvt_pk_bf16_f32 v111, v210, v211
    s_mov_b64 exec, 0x00030003
    buffer_store_dwordx2 v[110:111], v108, s[28:31], s48 offen sc0 sc1
    s_mov_b64 exec, -1
    s_branch L2_bc
L2_stre:
    s_add_u32 s49, s49, 1
    s_cmp_gt_u32 s49, 0x40000
    s_cbranch_scc1 L2_stok
    buffer_load_dwordx4 v[204:207], v9, s[28:31], s51 offen sc1
    s_branch L2_stw
L2_nokey:
    v_add_f32 v3, 1.0, v77
    v_mul_f32 v6, v76, v77
    v_fma_f32 v40, v60, v3, -v6
    v_fma_f32 v41, v61, v3, -v6
    v_fma_f32 v42, v62, v3, -v6
    v_fma_f32 v43, v63, v3, -v6
    v_fma_f32 v44, v64, v3, -v6
    v_fma_f32 v45, v65, v3, -v6
    v_fma_f32 v46, v66, v3, -v6
    v_fma_f32 v47, v67, v3, -v6
    v_cvt_pk_bf16_f32 v80, v40, v41
    v_cvt_pk_bf16_f32 v81, v42, v43
    v_cvt_pk_bf16_f32 v82, v44, v45
    v_cvt_pk_bf16_f32 v83, v46, v47
    s_waitcnt vmcnt(0)
    s_barrier
L2_bc:
    v_and_b32 v9, 15, v2
    v_lshrrev_b32 v10, 2, v9
    v_lshrrev_b32 v11, 4, v2
    v_lshl_add_u32 v10, v11, 3, v10
    v_lshlrev_b32 v10, 4, v10
    v_and_b32 v8, 1, v9
    v_lshl_add_u32 v10, v8, 3, v10
    s_mul_i32 s49, s45, 3
    v_add_u32 v10, s49, v10
    ds_read_b64_tr_b16 v[140:141], v10 offset:0
    ds_read_b64_tr_b16 v[142:143], v10 offset:64
    ds_read_b64_tr_b16 v[144:145], v10 offset:512
    ds_read_b64_tr_b16 v[146:147], v10 offset:576
    ds_read_b64_tr_b16 v[148:149], v10 offset:1024
    ds_read_b64_tr_b16 v[150:151], v10 offset:1088
    ds_read_b64_tr_b16 v[152:153], v10 offset:1536
    ds_read_b64_tr_b16 v[154:155], v10 offset:1600
    ds_read_b64_tr_b16 v[156:157], v10 offset:2048
    ds_read_b64_tr_b16 v[158:159], v10 offset:2112
    ds_read_b64_tr_b16 v[160:161], v10 offset:2560
    ds_read_b64_tr_b16 v[162:163], v10 offset:2624
    v_mov_b32 v0, 160912
    s_lshl_b32 s48, s41, 3
    v_add_u32 v8, s48, v106
    s_waitcnt lgkmcnt(0)
    s_barrier
    ds_read_b64 v[4:5], v0
    s_waitcnt lgkmcnt(0)
    v_not_b32 v4, v4
    v_not_b32 v5, v5
    v_and_b32 v4, 0x7ff, v4
    v_and_b32 v5, 0x7ff, v5
    v_cmp_ne_u32 vcc, v4, v8
    v_cmp_ne_u32 s[62:63], v5, v8
    s_and_b64 exec, vcc, s[62:63]
    buffer_store_dwordx4 v[80:83], v104, s[24:27], s44 offen
    s_mov_b64 exec, -1
    s_sub_u32 s48, s2, 176
    s_cmp_lt_u32 s48, 64
    s_cbranch_scc1 L2_st2
L2_fin:
    s_endpgm
L2_st2:
    v_and_b32 v6, 8, v2
    v_cmp_ne_u32 vcc, 0, v6
    s_mov_b32 s48, 4194304
    s_mov_b32 s51, 6356992
    v_cndmask_b32 v3, v4, v5, vcc
    v_lshlrev_b32 v12, 10, v3
    v_lshl_add_u32 v12, v1, 1, v12
    v_add_u32 v12, s61, v12
    v_lshlrev_b32 v18, 4, v3
    buffer_load_ushort v13, v12, s[28:31], s48 offen sc1
    v_and_b32 v6, 1, v2
    v_lshlrev_b32 v0, 7, v11
    v_lshl_add_u32 v0, v6, 4, v0
    s_mul_i32 s48, s40, 3072
    s_add_u32 s48, s48, 6422528
    s_mov_b32 s49, 0
L2_spoll:
    buffer_load_dwordx4 v[204:207], v18, s[28:31], s51 offen sc1
    s_add_u32 s49, s49, 1
    s_waitcnt vmcnt(0)
    v_cmp_ne_u32 vcc, s68, v207
    s_cmp_gt_u32 s49, 0x40000
    s_cbranch_scc1 L2_sgot
    s_cbranch_vccnz L2_spoll
L2_sgot:
    v_mul_f32 v16, 0xbfb8aa3b, v206
    v_exp_f32 v16, v16
    v_lshlrev_b32 v13, 16, v13
    v_add_f32 v16, 1.0, v16
    v_rcp_f32 v16, v16
    v_sub_f32 v17, v13, v204
    v_fma_f32 v13, v17, v205, v13
    v_and_b32 v3, 1, v11
    v_lshlrev_b32 v19, 5, v6
    v_lshl_add_u32 v19, v3, 4, v19
    s_lshl_b32 s50, s40, 6
    s_add_u32 s50, s50, 32768
    v_add_u32 v19, s50, v19
    v_lshlrev_b32 v10, 2, v9
    v_lshl_add_u32 v10, v11, 7, v10
    v_add_u32 v10, 32768, v10
L2_apoll:
    buffer_load_dwordx4 v[164:167], v0, s[28:31], s48 offen offset:0 sc1
    buffer_load_dwordx4 v[168:171], v0, s[28:31], s48 offen offset:512 sc1
    buffer_load_dwordx4 v[172:175], v0, s[28:31], s48 offen offset:1024 sc1
    buffer_load_dwordx4 v[176:179], v0, s[28:31], s48 offen offset:1536 sc1
    buffer_load_dwordx4 v[180:183], v0, s[28:31], s48 offen offset:2048 sc1
    buffer_load_dwordx4 v[184:187], v0, s[28:31], s48 offen offset:2560 sc1
    s_add_u32 s49, s49, 1
    s_waitcnt vmcnt(0)
    v_max3_u32 v3, v164, v165, v166
    v_max3_u32 v3, v167, v168, v3
    v_max3_u32 v3, v169, v170, v3
    v_max3_u32 v3, v171, v172, v3
    v_max3_u32 v3, v173, v174, v3
    v_max3_u32 v3, v175, v176, v3
    v_max3_u32 v3, v177, v178, v3
    v_max3_u32 v3, v179, v180, v3
    v_max3_u32 v3, v181, v182, v3
    v_max3_u32 v3, v183, v184, v3
    v_max3_u32 v3, v185, v186, v3
    v_max_u32 v3, v187, v3
    v_cmp_eq_u32 vcc, -1, v3
    s_cmp_gt_u32 s49, 0x40000
    s_cbranch_scc1 L2_agot
    s_cbranch_vccnz L2_apoll
L2_agot:
    s_mov_b64 exec, -1
    v_mfma_f32_16x16x32_bf16 v[208:211], v[140:143], v[164:167], 0
    v_mfma_f32_16x16x32_bf16 v[208:211], v[144:147], v[168:171], v[208:211]
    v_mfma_f32_16x16x32_bf16 v[208:211], v[148:151], v[172:175], v[208:211]
    v_mfma_f32_16x16x32_bf16 v[208:211], v[152:155], v[176:179], v[208:211]
    v_mfma_f32_16x16x32_bf16 v[208:211], v[156:159], v[180:183], v[208:211]
    v_mfma_f32_16x16x32_bf16 v[208:211], v[160:163], v[184:187], v[208:211]
    s_nop 7
    ds_write_b128 v19, v[208:211]
    s_waitcnt lgkmcnt(0)
    s_barrier
    s_cmp_lg_u32 s40, 0
    s_cbranch_scc1 L2_fin
    ds_read2_b32 v[14:15], v10 offset0:0 offset1:16
    s_waitcnt lgkmcnt(0)
    v_add_f32 v14, v14, v15
    v_mov_b32 v15, v14
    s_nop 1
    v_permlane32_swap_b32 v14, v15
    v_add_f32 v14, v14, v15
    v_mov_b32 v15, v14
    s_nop 1
    v_permlane16_swap_b32 v14, v15
    v_add_f32 v14, v14, v15
    v_fma_f32 v14, v14, v16, v13
    v_cvt_pk_bf16_f32 v14, v14, v14
    s_mov_b64 exec, 0xffff
    buffer_store_short v14, v12, s[24:27], 0 offen
L2_end:
    s_endpgm
L2_old:
    s_setprio 0
    v_mov_b32 v3, 160896
    v_mov_b32 v4, 1
    s_waitcnt lgkmcnt(0)
    s_mov_b64 exec, 1
    ds_add_u32 v3, v4
    s_mov_b64 exec, -1
    s_add_u32 s48, s51, 262144
    v_mov_b32 v7, 1552
    ds_read_b128 v[84:87], v7
    ds_read_b128 v[12:15], v7
    ds_read_b128 v[88:91], v7
    ds_read_b128 v[16:19], v7
    ds_read_b128 v[92:95], v7
    ds_read_b128 v[20:23], v7
    ds_read_b128 v[96:99], v7
    ds_read_b128 v[24:27], v7
    buffer_load_dwordx4 v[40:43], v103, s[28:31], s48 offen offset:0 sc1
    buffer_load_dwordx4 v[44:47], v103, s[28:31], s48 offen offset:1024 sc1
    buffer_load_dwordx4 v[48:51], v103, s[28:31], s48 offen offset:2048 sc1
    buffer_load_dwordx4 v[52:55], v103, s[28:31], s48 offen offset:3072 sc1
    s_add_u32 s48, s48, 4096
    buffer_load_dwordx4 v[56:59], v103, s[28:31], s48 offen offset:0 sc1
    buffer_load_dwordx4 v[60:63], v103, s[28:31], s48 offen offset:1024 sc1
    buffer_load_dwordx4 v[64:67], v103, s[28:31], s48 offen offset:2048 sc1
    buffer_load_dwordx4 v[68:71], v103, s[28:31], s48 offen offset:3072 sc1
    s_add_u32 s48, s48, 4096
    buffer_load_dwordx4 v[72:75], v103, s[28:31], s48 offen offset:0 sc1
    buffer_load_dwordx4 v[76:79], v103, s[28:31], s48 offen offset:1024 sc1
L2_spin:
    ds_read_b32 v4, v3
    s_waitcnt lgkmcnt(0)
    v_readfirstlane_b32 s49, v4
    s_cmp_ge_u32 s49, 4
    s_cbranch_scc1 L2_go
    s_sleep 2
    s_branch L2_spin
L2_go:
    ds_read_b128 v[8:11], v101 offset:0
    ds_read_b128 v[28:31], v101 offset:128
    ds_read_b128 v[32:35], v101 offset:256
    ds_read_b128 v[36:39], v101 offset:384
    s_add_u32 s49, s51, 53248
    s_waitcnt lgkmcnt(0)
    v_smfmac_f32_16x16x64_bf16 v[84:87], v[8:11], v[108:115], v100
    buffer_load_dwordx4 v[108:111], v103, s[28:31], s48 offen offset:2048 sc1
    buffer_load_dwordx4 v[112:115], v103, s[28:31], s48 offen offset:3072 sc1
    s_add_u32 s48, s48, 4096
    v_smfmac_f32_16x16x64_bf16 v[88:91], v[8:11], v[116:123], v100
    buffer_load_dwordx4 v[116:119], v103, s[28:31], s48 offen offset:0 sc1
    buffer_load_dwordx4 v[120:123], v103, s[28:31], s48 offen offset:1024 sc1
    v_smfmac_f32_16x16x64_bf16 v[92:95], v[8:11], v[124:131], v100
    buffer_load_dwordx4 v[124:127], v103, s[28:31], s48 offen offset:2048 sc1
    buffer_load_dwordx4 v[128:131], v103, s[28:31], s48 offen offset:3072 sc1
    s_add_u32 s48, s48, 4096
    v_smfmac_f32_16x16x64_bf16 v[96:99], v[8:11], v[132:139], v100
    buffer_load_dwordx4 v[132:135], v103, s[28:31], s48 offen offset:0 sc1
    buffer_load_dwordx4 v[136:139], v103, s[28:31], s48 offen offset:1024 sc1
    v_smfmac_f32_16x16x64_bf16 v[84:87], v[28:31], v[140:147], v100
    buffer_load_dwordx4 v[140:143], v103, s[28:31], s48 offen offset:2048 sc1
    buffer_load_dwordx4 v[144:147], v103, s[28:31], s48 offen offset:3072 sc1
    s_add_u32 s48, s48, 4096
    v_smfmac_f32_16x16x64_bf16 v[88:91], v[28:31], v[148:155], v100
    buffer_load_dwordx4 v[148:151], v103, s[28:31], s48 offen offset:0 sc1
    buffer_load_dwordx4 v[152:155], v103, s[28:31], s48 offen offset:1024 sc1
    v_smfmac_f32_16x16x64_bf16 v[92:95], v[28:31], v[156:163], v100
    buffer_load_dwordx4 v[156:159], v103, s[28:31], s48 offen offset:2048 sc1
    buffer_load_dwordx4 v[160:163], v103, s[28:31], s48 offen offset:3072 sc1
    s_add_u32 s48, s48, 4096
    v_smfmac_f32_16x16x64_bf16 v[96:99], v[28:31], v[164:171], v100
    buffer_load_dwordx4 v[164:167], v103, s[28:31], s48 offen offset:0 sc1
    buffer_load_dwordx4 v[168:171], v103, s[28:31], s48 offen offset:1024 sc1
    v_smfmac_f32_16x16x64_bf16 v[84:87], v[32:35], v[172:179], v100
    buffer_load_dwordx4 v[172:175], v103, s[28:31], s48 offen offset:2048 sc1
    buffer_load_dwordx4 v[176:179], v103, s[28:31], s48 offen offset:3072 sc1
    s_add_u32 s48, s48, 4096
    v_smfmac_f32_16x16x64_bf16 v[88:91], v[32:35], v[180:187], v100
    buffer_load_dwordx4 v[180:183], v103, s[28:31], s48 offen offset:0 sc1
    buffer_load_dwordx4 v[184:187], v103, s[28:31], s48 offen offset:1024 sc1
    v_smfmac_f32_16x16x64_bf16 v[92:95], v[32:35], v[188:195], v100
    buffer_load_dwordx4 v[188:191], v103, s[28:31], s48 offen offset:2048 sc1
    buffer_load_dwordx4 v[192:195], v103, s[28:31], s48 offen offset:3072 sc1
    s_add_u32 s48, s48, 4096
    v_smfmac_f32_16x16x64_bf16 v[96:99], v[32:35], v[196:203], v100
    buffer_load_dwordx4 v[196:199], v103, s[28:31], s49 offen offset:2048 sc1
    buffer_load_dwordx4 v[200:203], v103, s[28:31], s49 offen offset:3072 sc1
    s_add_u32 s49, s49, 4096
    v_smfmac_f32_16x16x64_bf16 v[84:87], v[36:39], v[204:211], v100
    buffer_load_dwordx4 v[204:207], v103, s[28:31], s49 offen offset:0 sc1
    buffer_load_dwordx4 v[208:211], v103, s[28:31], s49 offen offset:1024 sc1
    v_smfmac_f32_16x16x64_bf16 v[88:91], v[36:39], v[212:219], v100
    buffer_load_dwordx4 v[212:215], v103, s[28:31], s49 offen offset:2048 sc1
    buffer_load_dwordx4 v[216:219], v103, s[28:31], s49 offen offset:3072 sc1
    s_add_u32 s49, s49, 4096
    v_smfmac_f32_16x16x64_bf16 v[92:95], v[36:39], v[220:227], v100
    buffer_load_dwordx4 v[220:223], v103, s[28:31], s49 offen offset:0 sc1
    buffer_load_dwordx4 v[224:227], v103, s[28:31], s49 offen offset:1024 sc1
    v_smfmac_f32_16x16x64_bf16 v[96:99], v[36:39], v[228:235], v100
    buffer_load_dwordx4 v[228:231], v103, s[28:31], s49 offen offset:2048 sc1
    buffer_load_dwordx4 v[232:235], v103, s[28:31], s49 offen offset:3072 sc1
    s_add_u32 s49, s49, 4096
    s_add_u32 s49, s51, 32768
    s_waitcnt vmcnt(40)
    v_smfmac_f32_16x16x64_bf16 v[12:15], v[8:11], v[40:47], v100
    s_waitcnt vmcnt(38)
    v_smfmac_f32_16x16x64_bf16 v[16:19], v[8:11], v[48:55], v100
    s_waitcnt vmcnt(36)
    v_smfmac_f32_16x16x64_bf16 v[20:23], v[8:11], v[56:63], v100
    s_waitcnt vmcnt(34)
    v_smfmac_f32_16x16x64_bf16 v[24:27], v[8:11], v[64:71], v100
    s_waitcnt vmcnt(32)
    v_smfmac_f32_16x16x64_bf16 v[12:15], v[28:31], v[72:79], v100
    s_waitcnt vmcnt(30)
    v_smfmac_f32_16x16x64_bf16 v[16:19], v[28:31], v[108:115], v100
    buffer_load_dwordx4 v[108:111], v103, s[28:31], s49 offen offset:0 sc1
    buffer_load_dwordx4 v[112:115], v103, s[28:31], s49 offen offset:1024 sc1
    s_waitcnt vmcnt(30)
    v_smfmac_f32_16x16x64_bf16 v[20:23], v[28:31], v[116:123], v100
    buffer_load_dwordx4 v[116:119], v103, s[28:31], s49 offen offset:2048 sc1
    buffer_load_dwordx4 v[120:123], v103, s[28:31], s49 offen offset:3072 sc1
    s_add_u32 s49, s49, 4096
    s_waitcnt vmcnt(30)
    v_smfmac_f32_16x16x64_bf16 v[24:27], v[28:31], v[124:131], v100
    buffer_load_dwordx4 v[124:127], v103, s[28:31], s49 offen offset:0 sc1
    buffer_load_dwordx4 v[128:131], v103, s[28:31], s49 offen offset:1024 sc1
    s_waitcnt vmcnt(30)
    v_smfmac_f32_16x16x64_bf16 v[12:15], v[32:35], v[132:139], v100
    buffer_load_dwordx4 v[132:135], v103, s[28:31], s49 offen offset:2048 sc1
    buffer_load_dwordx4 v[136:139], v103, s[28:31], s49 offen offset:3072 sc1
    s_add_u32 s49, s49, 4096
    s_waitcnt vmcnt(30)
    v_smfmac_f32_16x16x64_bf16 v[16:19], v[32:35], v[140:147], v100
    buffer_load_dwordx4 v[140:143], v103, s[28:31], s49 offen offset:0 sc1
    buffer_load_dwordx4 v[144:147], v103, s[28:31], s49 offen offset:1024 sc1
    s_waitcnt vmcnt(30)
    v_smfmac_f32_16x16x64_bf16 v[20:23], v[32:35], v[148:155], v100
    buffer_load_dwordx4 v[148:151], v103, s[28:31], s49 offen offset:2048 sc1
    buffer_load_dwordx4 v[152:155], v103, s[28:31], s49 offen offset:3072 sc1
    s_add_u32 s49, s49, 4096
    s_waitcnt vmcnt(30)
    v_smfmac_f32_16x16x64_bf16 v[24:27], v[32:35], v[156:163], v100
    buffer_load_dwordx4 v[156:159], v103, s[28:31], s49 offen offset:0 sc1
    buffer_load_dwordx4 v[160:163], v103, s[28:31], s49 offen offset:1024 sc1
    s_waitcnt vmcnt(30)
    v_smfmac_f32_16x16x64_bf16 v[12:15], v[36:39], v[164:171], v100
    buffer_load_dwordx4 v[164:167], v103, s[28:31], s49 offen offset:2048 sc1
    buffer_load_dwordx4 v[168:171], v103, s[28:31], s49 offen offset:3072 sc1
    s_add_u32 s49, s49, 4096
    s_waitcnt vmcnt(30)
    v_smfmac_f32_16x16x64_bf16 v[16:19], v[36:39], v[172:179], v100
    buffer_load_dwordx4 v[172:175], v103, s[28:31], s49 offen offset:0 sc1
    buffer_load_dwordx4 v[176:179], v103, s[28:31], s49 offen offset:1024 sc1
    s_waitcnt vmcnt(30)
    v_smfmac_f32_16x16x64_bf16 v[20:23], v[36:39], v[180:187], v100
    buffer_load_dwordx4 v[180:183], v103, s[28:31], s49 offen offset:2048 sc1
    buffer_load_dwordx4 v[184:187], v103, s[28:31], s49 offen offset:3072 sc1
    s_add_u32 s49, s49, 4096
    s_waitcnt vmcnt(30)
    v_smfmac_f32_16x16x64_bf16 v[24:27], v[36:39], v[188:195], v100
    buffer_load_dwordx4 v[188:191], v103, s[28:31], s49 offen offset:0 sc1
    buffer_load_dwordx4 v[192:195], v103, s[28:31], s49 offen offset:1024 sc1
    s_nop 5
    ds_write_b128 v102, v[12:15] offset:0
    ds_write_b128 v102, v[16:19] offset:1024
    ds_write_b128 v102, v[20:23] offset:2048
    ds_write_b128 v102, v[24:27] offset:3072
    s_waitcnt vmcnt(0)
    s_setprio 1
    s_branch L2_join
L2_slow:
    v_mov_b32 v101, v103
    v_mov_b32 v106, 0xff7fffff
    s_mov_b32 s43, 64
L2_maxloop:
    ds_read_b128 v[28:31], v101
    v_add_u32 v101, 2112, v101
    s_waitcnt lgkmcnt(0)
    v_mfma_f32_32x32x16_bf16 v[52:67], v[28:31], v[8:11], 0
    s_sub_u32 s43, s43, 1
    s_nop 10
    v_max3_f32 v106, v52, v53, v106
    v_max3_f32 v106, v54, v55, v106
    v_max3_f32 v106, v56, v57, v106
    v_max3_f32 v106, v58, v59, v106
    v_max3_f32 v106, v60, v61, v106
    v_max3_f32 v106, v62, v63, v106
    v_max3_f32 v106, v64, v65, v106
    v_max3_f32 v106, v66, v67, v106
    s_cmp_lg_u32 s43, 0
    s_cbranch_scc1 L2_maxloop
    v_mov_b32 v3, v106
    v_mov_b32 v101, v103
    v_mov_b32 v102, v107
    v_permlane32_swap_b32 v106, v3
    v_max_f32 v106, v106, v3
    v_mov_b32 v84, 0
    v_mov_b32 v85, 0
    v_mov_b32 v86, 0
    v_mov_b32 v87, 0
    v_mov_b32 v88, 0
    v_mov_b32 v89, 0
    v_mov_b32 v90, 0
    v_mov_b32 v91, 0
    v_mov_b32 v92, 0
    v_mov_b32 v93, 0
    v_mov_b32 v94, 0
    v_mov_b32 v95, 0
    v_mov_b32 v96, 0
    v_mov_b32 v97, 0
    v_mov_b32 v98, 0
    v_mov_b32 v99, 0
    s_mov_b32 s43, 64
L2_slowloop:
    ds_read_b128 v[28:31], v101
    ds_read_b128 v[36:39], v102
    ds_read_b128 v[40:43], v102 offset:544
    v_add_u32 v101, 2112, v101
    v_add_u32 v102, 2112, v102
    s_waitcnt lgkmcnt(0)
    v_mfma_f32_32x32x16_bf16 v[52:67], v[28:31], v[8:11], 0
    s_sub_u32 s43, s43, 1
    s_nop 10
    v_sub_f32 v52, v52, v106
    v_sub_f32 v53, v53, v106
    v_sub_f32 v54, v54, v106
    v_sub_f32 v55, v55, v106
    v_sub_f32 v56, v56, v106
    v_sub_f32 v57, v57, v106
    v_sub_f32 v58, v58, v106
    v_sub_f32 v59, v59, v106
    v_sub_f32 v60, v60, v106
    v_sub_f32 v61, v61, v106
    v_sub_f32 v62, v62, v106
    v_sub_f32 v63, v63, v106
    v_sub_f32 v64, v64, v106
    v_sub_f32 v65, v65, v106
    v_sub_f32 v66, v66, v106
    v_sub_f32 v67, v67, v106
    v_exp_f32 v52, v52
    v_exp_f32 v53, v53
    v_exp_f32 v54, v54
    v_exp_f32 v55, v55
    v_exp_f32 v56, v56
    v_exp_f32 v57, v57
    v_exp_f32 v58, v58
    v_exp_f32 v59, v59
    v_exp_f32 v60, v60
    v_exp_f32 v61, v61
    v_exp_f32 v62, v62
    v_exp_f32 v63, v63
    v_exp_f32 v64, v64
    v_exp_f32 v65, v65
    v_exp_f32 v66, v66
    v_exp_f32 v67, v67
    s_nop 1
    v_smfmac_f32_32x32x32_bf16 v[84:99], v[36:39], v[52:59], v100
    v_smfmac_f32_32x32x32_bf16 v[84:99], v[40:43], v[60:67], v100
    s_cmp_lg_u32 s43, 0
    s_cbranch_scc1 L2_slowloop
    s_nop 11
    v_rcp_f32 v3, v92
    s_branch L2_epi
L1_tag:
    s_mov_b32 s47, 0
L1_tagl:
    buffer_load_dword v66, v94, s[28:31], 0 offen sc1
    s_add_u32 s47, s47, 1
    s_waitcnt vmcnt(0)
    v_readfirstlane_b32 s68, v66
    s_cmp_gt_u32 s47, 0x40000
    s_cbranch_scc1 L1_tagx
    s_cmp_eq_u32 s68, 0
    s_cbranch_scc1 L1_tagl
L1_tagx:
    s_branch L1_tagok
.section .rodata,"a"
.p2align 6
.amdhsa_kernel sequential_preLN__grouped_kv_mqa__moe_arch_mod__prompt_kernel
  .amdhsa_next_free_vgpr 256
  .amdhsa_next_free_sgpr 72
  .amdhsa_accum_offset 256
  .amdhsa_group_segment_fixed_size 0
  .amdhsa_kernarg_size 104
  .amdhsa_user_sgpr_count 2
  .amdhsa_user_sgpr_kernarg_segment_ptr 1
  .amdhsa_system_sgpr_workgroup_id_x 1
.end_amdhsa_kernel
```
